```python
import torch

def _softmax(x, axis=-1):
    return torch.softmax(x, dim=axis)
def _gelu(x):
    return torch.nn.functional.gelu(x, approximate="tanh")
def _silu(x):
    return torch.nn.functional.silu(x)
def _sigmoid(x):
    return torch.sigmoid(x)
def _layernorm(x, axis=-1, eps=1e-5):
    m = x.mean(dim=axis, keepdim=True)
    v = x.var(dim=axis, keepdim=True, unbiased=False)
    return (x - m) / torch.sqrt(v + eps)
def _scatter_add(tgt, idx, src, axis=0):
    return tgt.clone().index_add_(axis, idx, src)
def _segment_sum(src, seg, n):
    out = torch.zeros((n,) + src.shape[1:], dtype=src.dtype)
    return out.index_add_(0, seg, src)
def _pad(x, pw):
    flat = tuple(v for pair in reversed(pw) for v in pair)
    return torch.nn.functional.pad(x, flat)

kernel_name = 'sequential_preLN__sliding_block_cached__mixer_channel_mlp__decode'

def setup_inputs():

    _w = (lambda a: (lambda t: t.to(torch.bfloat16) if t.is_floating_point() else t)(torch.as_tensor(a)))
    def _A_setup():
        B, Sq, D = 2, 1, 640
        Hq, Hkv, Sk, Dh = 32, 32, 4096, 128
        assert Hq % Hkv == 0, (Hq, Hkv)
        return {
            "x": _w((lambda *s: torch.randn(*s, dtype=torch.bfloat16) * 0.05)(B, Sq, D)),
            "k_cache": _w((lambda *s: torch.randn(*s, dtype=torch.bfloat16) * 3.2)(B, Hkv, Sk, Dh)),
            "v_cache": _w((lambda *s: torch.randn(*s, dtype=torch.bfloat16) * 0.4)(B, Hkv, Sk, Dh)),
            "wq": _w((lambda *s: torch.randn(*s, dtype=torch.bfloat16) * 3.2)(D, Hq * Dh) * (D ** -0.5)),
            "wo": _w((lambda *s: torch.randn(*s, dtype=torch.bfloat16) * 0.4)(Hq * Dh, D) * ((Hq * Dh) ** -0.5)),
        }
    _A_in = _A_setup()

    def _B_setup():
        B, S, D, F = 2, 1, 640, 1728
        return {
            "x": _w((lambda *s: torch.randn(*s, dtype=torch.bfloat16) * 0.05)(B, S, D)),
            "w1": _w((lambda *s: torch.randn(*s, dtype=torch.bfloat16) * 3.2)(D, F) * (D ** -0.5)),
            "b1": _w((lambda *s: torch.randn(*s, dtype=torch.bfloat16) * 1.6)(F)),
            "w2": _w((lambda *s: torch.randn(*s, dtype=torch.bfloat16) * 0.1)(F, D) * (F ** -0.5)),
            "b2": _w((lambda *s: torch.randn(*s, dtype=torch.bfloat16) * 0.1)(D)),
        }
    _B_in = _B_setup()

    return {
        "A_x": _A_in["x"],
        "A_k_cache": _A_in["k_cache"],
        "A_v_cache": _A_in["v_cache"],
        "A_wq": _A_in["wq"],
        "A_wo": _A_in["wo"],
        "B_x": _B_in["x"],
        "B_w1": _B_in["w1"],
        "B_b1": _B_in["b1"],
        "B_w2": _B_in["w2"],
        "B_b2": _B_in["b2"],
    }

def reference(A_x, A_k_cache, A_v_cache, A_wq, A_wo, B_x, B_w1, B_b1, B_w2, B_b2):
    def _A_ref(x, k_cache, v_cache, wq, wo):
        B, Sq, D = x.shape
        Hq, Dh = 32, 128
        Hkv, Sk = k_cache.shape[1], k_cache.shape[2]
        W = min(4096, max(256, Sk // 4))
        rep = Hq // Hkv
        q = (lambda x, *d: x.permute(*d))((x @ wq).reshape(B, Sq, Hq, Dh), 0, 2, 1, 3)
        k = (lambda x, n, axis: torch.repeat_interleave(x, n, dim=axis))(k_cache[:, :, Sk - W:, :], rep, axis=1)
        v = (lambda x, n, axis: torch.repeat_interleave(x, n, dim=axis))(v_cache[:, :, Sk - W:, :], rep, axis=1)
        scores = torch.einsum("bhqd,bhkd->bhqk", q, k) * (Dh ** -0.5)
        p = _softmax(scores, axis=-1)
        o = torch.einsum("bhqk,bhkd->bhqd", p, v)
        return (lambda x, *d: x.permute(*d))(o, 0, 2, 1, 3).reshape(B, Sq, Hq * Dh) @ wo

    def _B_ref(x, w1, b1, w2, b2):
        y = _layernorm(x, axis=-1)
        h = _gelu(torch.einsum("bsd,df->bsf", y, w1) + b1)
        return torch.einsum("bsf,fd->bsd", h, w2) + b2

    x = A_x
    h = x + _A_ref(_layernorm(x, axis=-1), A_k_cache, A_v_cache, A_wq, A_wo)
    h2 = h + _B_ref(_layernorm(h, axis=-1), B_w1, B_b1, B_w2, B_b2)
    return h2
```

```asm
; @launch grid=(256,1,1) block=(320,1,1) lds=98304
.amdgcn_target "amdgcn-amd-amdhsa--gfx950"
.text
.globl sequential_preLN__sliding_block_cached__mixer_channel_mlp__decode_kernel
.p2align 8
.type sequential_preLN__sliding_block_cached__mixer_channel_mlp__decode_kernel,@function
sequential_preLN__sliding_block_cached__mixer_channel_mlp__decode_kernel:
    s_load_dwordx16 s[4:19], s[0:1], 0
    s_load_dwordx8 s[20:27], s[0:1], 64
    s_load_dwordx2 s[28:29], s[0:1], 96
    v_cmp_lt_u32 vcc, 63, v0
    s_cmp_ge_u32 s2, 256
    s_cbranch_scc1 L_exit
    s_cbranch_vccnz L_tramp
    s_setprio 3
    s_and_b32 s30, s2, 7
    s_lshr_b32 s31, s2, 3
    s_lshl_b32 s34, s30, 5
    s_add_u32 s34, s34, s31
    s_lshr_b32 s32, s34, 3
    s_and_b32 s33, s34, 7
    s_getpc_b64 s[36:37]
L_pc:
    s_lshl_b32 s35, s33, 11
    v_and_b32 v12, 15, v0
    v_lshl_add_u32 v1, v12, 7, s35
    v_min_u32 v1, L_codeend-L_pc-4, v1
    global_load_dword v254, v1, s[36:37]
    s_mul_i32 s35, s33, 2560
    s_add_u32 s35, s35, s32
    s_lshl_b32 s35, s35, 8
    v_lshrrev_b32 v3, 4, v0
    v_mul_u32_u24 v3, 163840, v3
    v_lshl_add_u32 v3, v12, 4, v3
    v_add_u32 v3, s35, v3
    v_lshlrev_b32 v1, 3, v0
    v_lshlrev_b32 v2, 2, v0
    s_movk_i32 s38, 0x2000
    s_waitcnt lgkmcnt(0)
    global_load_dwordx2 v[24:25], v1, s[4:5]
    global_load_dwordx2 v[26:27], v1, s[4:5] offset:512
    global_load_dword v28, v2, s[4:5] offset:1024
    global_load_dwordx2 v[30:31], v1, s[4:5] offset:1280
    global_load_dwordx2 v[32:33], v1, s[4:5] offset:1792
    global_load_dword v34, v2, s[4:5] offset:2304
    global_load_dwordx4 v[80:83], v3, s[10:11] nt
    v_add_u32 v3, s38, v3
    global_load_dwordx4 v[84:87], v3, s[10:11] nt
    v_add_u32 v3, s38, v3
    global_load_dwordx4 v[88:91], v3, s[10:11] nt
    v_add_u32 v3, s38, v3
    s_branch L_c2
.if (. - sequential_preLN__sliding_block_cached__mixer_channel_mlp__decode_kernel) > 256
.error "first block too long"
.endif
.p2align 8
L_tramp:
    s_branch L_att
L_c2:
    s_lshl_b32 s45, s34, 12
    s_add_u32 s45, s45, 1048576
    v_and_b32 v12, 7, v0
    v_lshl_add_u32 v20, v12, 7, s45
    v_mov_b32 v12, 524288
    global_load_dword v15, v12, s[28:29] sc1
    global_load_dword v253, v20, s[28:29] nt
    global_load_dwordx4 v[92:95], v3, s[10:11] nt
    v_add_u32 v3, s38, v3
    global_load_dwordx4 v[96:99], v3, s[10:11] nt
    v_add_u32 v3, s38, v3
    v_mov_b32 v36, 0
    ds_write_b32 v2, v36 offset:3072
    s_mov_b32 s3, 4
    global_load_dwordx4 v[100:103], v3, s[10:11] nt
    v_add_u32 v3, s38, v3
    global_load_dwordx4 v[104:107], v3, s[10:11] nt
    v_add_u32 v3, s38, v3
    global_load_dwordx4 v[108:111], v3, s[10:11] nt
    v_add_u32 v3, s38, v3
    global_load_dwordx4 v[112:115], v3, s[10:11] nt
    v_add_u32 v3, s38, v3
    global_load_dwordx4 v[116:119], v3, s[10:11] nt
    v_add_u32 v3, s38, v3
    global_load_dwordx4 v[120:123], v3, s[10:11] nt
    v_add_u32 v3, s38, v3
    global_load_dwordx4 v[124:127], v3, s[10:11] nt
    v_add_u32 v3, s38, v3
    global_load_dwordx4 v[128:131], v3, s[10:11] nt
    v_add_u32 v3, s38, v3
    global_load_dwordx4 v[132:135], v3, s[10:11] nt
    v_add_u32 v3, s38, v3
    global_load_dwordx4 v[136:139], v3, s[10:11] nt
    v_add_u32 v3, s38, v3
    global_load_dwordx4 v[140:143], v3, s[10:11] nt
    v_add_u32 v3, s38, v3
    global_load_dwordx4 v[144:147], v3, s[10:11] nt
    v_add_u32 v3, s38, v3
    global_load_dwordx4 v[148:151], v3, s[10:11] nt
    v_add_u32 v3, s38, v3
    global_load_dwordx4 v[152:155], v3, s[10:11] nt
    v_add_u32 v3, s38, v3
    global_load_dwordx4 v[156:159], v3, s[10:11] nt
    s_waitcnt lgkmcnt(0)
    s_barrier
    s_branch L_ctrl
L_att:
    v_lshrrev_b32 v1, 6, v0
    v_and_b32 v0, 63, v0
    v_readfirstlane_b32 s3, v1
    s_and_b32 s30, s2, 7
    s_lshr_b32 s31, s2, 3
    s_lshl_b32 s34, s30, 5
    s_add_u32 s34, s34, s31
    s_lshr_b32 s32, s34, 3
    s_and_b32 s33, s34, 7
    s_sub_u32 s3, s3, 1
    s_lshr_b32 s35, s33, 2
    s_lshl_b32 s35, s35, 5
    s_add_u32 s35, s35, s32
    s_lshl_b32 s35, s35, 4
    s_and_b32 s36, s33, 3
    s_add_u32 s35, s35, s36
    s_add_u32 s35, s35, 12
    s_lshl_b32 s35, s35, 3
    s_add_u32 s35, s35, s3
    s_lshl_b32 s35, s35, 13
    s_add_u32 s35, s35, 4096
    v_bfe_u32 v1, v0, 2, 2
    v_lshlrev_b32 v1, 8, v1
    v_lshrrev_b32 v2, 4, v0
    v_lshl_add_u32 v1, v2, 6, v1
    v_and_b32 v2, 3, v0
    v_lshl_add_u32 v1, v2, 4, v1
    v_add_u32 v1, s35, v1
    v_lshl_add_u32 v14, v0, 4, s35
    s_waitcnt lgkmcnt(0)
    s_barrier
    global_load_dwordx4 v[16:19], v1, s[6:7] offset:-4096 nt
    global_load_dwordx4 v[20:23], v1, s[6:7] offset:-3072 nt
    global_load_dwordx4 v[24:27], v1, s[6:7] offset:-2048 nt
    global_load_dwordx4 v[28:31], v1, s[6:7] offset:-1024 nt
    global_load_dwordx4 v[32:35], v1, s[6:7] offset:0 nt
    global_load_dwordx4 v[36:39], v1, s[6:7] offset:1024 nt
    global_load_dwordx4 v[40:43], v1, s[6:7] offset:2048 nt
    global_load_dwordx4 v[44:47], v1, s[6:7] offset:3072 nt
    v_add_u32 v1, 32768, v1
    global_load_dwordx4 v[48:51], v1, s[6:7] offset:-4096 nt
    global_load_dwordx4 v[52:55], v1, s[6:7] offset:-3072 nt
    global_load_dwordx4 v[56:59], v1, s[6:7] offset:-2048 nt
    v_and_b32 v2, 1, v0
    v_cmp_eq_u32 vcc, 1, v2
    v_mov_b32 v2, 0x0c0c0100
    v_mov_b32 v3, 0x01000c0c
    v_cndmask_b32 v12, v2, v3, vcc
    v_mov_b32 v2, 0x0c0c0302
    v_mov_b32 v3, 0x03020c0c
    v_cndmask_b32 v13, v2, v3, vcc
    v_bfe_u32 v2, v0, 1, 2
    v_mov_b32 v3, 0x0c0c0c0c
    v_cmp_eq_u32 vcc, 0, v2
    s_nop 1
    v_cndmask_b32 v4, v3, v12, vcc
    v_cndmask_b32 v8, v3, v13, vcc
    v_cmp_eq_u32 vcc, 1, v2
    s_nop 1
    v_cndmask_b32 v5, v3, v12, vcc
    v_cndmask_b32 v9, v3, v13, vcc
    v_cmp_eq_u32 vcc, 2, v2
    s_nop 1
    v_cndmask_b32 v6, v3, v12, vcc
    v_cndmask_b32 v10, v3, v13, vcc
    v_cmp_eq_u32 vcc, 3, v2
    s_nop 1
    v_cndmask_b32 v7, v3, v12, vcc
    v_cndmask_b32 v11, v3, v13, vcc
    v_and_b32 v2, 8, v0
    v_cmp_eq_u32 vcc, 8, v2
    s_nop 1
    v_cndmask_b32 v240, v4, v8, vcc
    v_cndmask_b32 v241, v5, v9, vcc
    v_cndmask_b32 v242, v6, v10, vcc
    v_cndmask_b32 v243, v7, v11, vcc
    v_lshrrev_b32 v2, 4, v0
    v_and_b32 v3, 3, v0
    v_lshl_add_u32 v2, v2, 2, v3
    v_lshlrev_b32 v2, 4, v2
    v_add_u32 v2, 2816, v2
    v_bfe_u32 v3, v0, 2, 2
    v_mov_b32 v12, 3200
    v_cmp_eq_u32 vcc, 0, v3
    s_nop 1
    v_cndmask_b32 v200, v12, v2, vcc
    v_cmp_eq_u32 vcc, 1, v3
    s_nop 1
    v_cndmask_b32 v201, v12, v2, vcc
    v_cmp_eq_u32 vcc, 2, v3
    s_nop 1
    v_cndmask_b32 v202, v12, v2, vcc
    v_cmp_eq_u32 vcc, 3, v3
    s_nop 1
    v_cndmask_b32 v203, v12, v2, vcc
    v_and_b32 v248, 15, v0
    v_lshlrev_b32 v248, 5, v248
    v_and_b32 v3, 16, v0
    v_add_u32 v248, v248, v3
    v_lshrrev_b32 v3, 5, v0
    v_mul_u32_u24 v3, 512, v3
    v_add_u32 v248, v248, v3
    s_lshl_b32 s36, s3, 10
    v_add_u32 v248, s36, v248
    s_lshl_b32 s36, s32, 13
    s_add_u32 s36, s36, 266240
    v_and_b32 v2, 8, v0
    v_lshlrev_b32 v2, 3, v2
    v_and_b32 v3, 3, v0
    v_lshl_add_u32 v2, v3, 4, v2
    v_add_u32 v247, s36, v2
    s_mov_b32 s40, 0x3db504f3
    s_mov_b32 s48, 0x3fb8aa3b
    s_mov_b32 s49, 0xffffff00
    s_lshl_b32 s36, s3, 3
    v_mov_b32 v12, s36
    v_mov_b32 v13, 0
    s_mov_b32 s47, 0
    s_waitcnt lgkmcnt(0)
    s_cmp_ge_u32 s33, 5
    s_cbranch_scc1 L_att_n
    s_lshl_b32 s36, s32, 2
    s_add_u32 s36, s36, s3
    s_mul_i32 s36, s36, 40960
    s_lshl_b32 s37, s33, 8
    s_add_u32 s36, s36, s37
    s_add_u32 s36, s36, 3840
    v_lshrrev_b32 v2, 4, v0
    v_mul_u32_u24 v2, 10240, v2
    v_and_b32 v3, 15, v0
    v_lshl_add_u32 v2, v3, 4, v2
    v_add_u32 v15, s36, v2
    s_lshl_b32 s35, s32, 3
    s_add_u32 s35, s35, s3
    s_lshl_b32 s35, s35, 10
    s_add_u32 s35, s35, 262144
    v_lshl_add_u32 v249, v0, 4, s35
    s_lshr_b32 s35, s3, 1
    s_mul_i32 s35, s35, 640
    s_lshl_b32 s36, s33, 7
    s_add_u32 s35, s35, s36
    s_and_b32 s36, s3, 1
    s_lshl_b32 s36, s36, 6
    s_add_u32 s35, s35, s36
    s_lshl_b32 s35, s35, 3
    v_lshl_add_u32 v250, v0, 3, s35
    s_lshl_b32 s35, s3, 8
    v_lshl_add_u32 v251, v0, 2, s35
    s_and_b32 s35, s32, 3
    s_lshl_b32 s35, s35, 3
    s_add_u32 s59, s35, s30
    s_min_u32 s35, s59, 26
    s_mul_i32 s35, s35, 20
    s_lshl_b32 s36, s33, 2
    s_add_u32 s35, s35, s36
    s_add_u32 s35, s35, s3
    s_lshl_b32 s35, s35, 12
    v_and_b32 v2, 31, v0
    v_lshl_add_u32 v252, v2, 7, s35
    s_mov_b32 s60, 0
    s_mov_b32 s61, 1096286208
    s_waitcnt vmcnt(8)
    global_load_dwordx4 v[208:211], v15, s[12:13] offset:-3840 nt
    s_waitcnt vmcnt(8)
    global_load_dwordx4 v[60:63], v1, s[6:7] offset:-1024 nt
    ds_write_b32 v12, v247 offset:3264
    s_waitcnt vmcnt(8)
    global_load_dwordx4 v[64:67], v1, s[6:7] offset:0 nt
    s_waitcnt vmcnt(8)
    global_load_dwordx4 v[68:71], v1, s[6:7] offset:1024 nt
    s_waitcnt vmcnt(8)
    global_load_dwordx4 v[72:75], v1, s[6:7] offset:2048 nt
    s_waitcnt vmcnt(8)
    global_load_dwordx4 v[76:79], v1, s[6:7] offset:3072 nt
    s_waitcnt vmcnt(8)
    global_load_dwordx4 v[80:83], v14, s[8:9] offset:-4096 nt
    s_waitcnt vmcnt(8)
    global_load_dwordx4 v[212:215], v15, s[12:13] offset:-2560 nt
    s_waitcnt vmcnt(8)
    global_load_dwordx4 v[84:87], v14, s[8:9] offset:-3072 nt
    s_waitcnt vmcnt(8)
    global_load_dwordx4 v[88:91], v14, s[8:9] offset:-2048 nt
    s_waitcnt vmcnt(8)
    global_load_dwordx4 v[92:95], v14, s[8:9] offset:-1024 nt
    s_waitcnt vmcnt(8)
    global_load_dwordx4 v[96:99], v14, s[8:9] offset:0 nt
    s_waitcnt vmcnt(8)
    global_load_dwordx4 v[100:103], v14, s[8:9] offset:1024 nt
    s_waitcnt vmcnt(8)
    global_load_dwordx4 v[104:107], v14, s[8:9] offset:2048 nt
    s_waitcnt vmcnt(8)
    global_load_dwordx4 v[216:219], v15, s[12:13] offset:-1280 nt
    ds_read_b64 v[2:3], v13 offset:3216
    s_waitcnt lgkmcnt(0)
    v_readfirstlane_b32 s47, v3
    s_nop 0
    s_cmp_eq_u32 s47, 0
    s_cbranch_scc1 L_chk_1
    s_call_b64 s[50:51], L_compute
L_chk_1:
    global_load_dwordx4 v[108:111], v14, s[8:9] offset:3072 nt
    s_cmp_lg_u32 s47, 0
    s_cbranch_scc1 L_chk_2
    ds_read_b64 v[2:3], v13 offset:3216
    s_waitcnt lgkmcnt(0)
    v_readfirstlane_b32 s47, v3
    s_nop 0
    s_cmp_eq_u32 s47, 0
    s_cbranch_scc1 L_chk_2
    s_call_b64 s[50:51], L_compute
L_chk_2:
    s_waitcnt vmcnt(9)
    v_add_u32 v14, 32768, v14
    global_load_dwordx4 v[112:115], v14, s[8:9] offset:-4096 nt
    s_cmp_lg_u32 s47, 0
    s_cbranch_scc1 L_chk_3
    ds_read_b64 v[2:3], v13 offset:3216
    s_waitcnt lgkmcnt(0)
    v_readfirstlane_b32 s47, v3
    s_nop 0
    s_cmp_eq_u32 s47, 0
    s_cbranch_scc1 L_chk_3
    s_call_b64 s[50:51], L_compute
L_chk_3:
    s_waitcnt vmcnt(9)
    global_load_dwordx4 v[116:119], v14, s[8:9] offset:-3072 nt
    s_cmp_lg_u32 s47, 0
    s_cbranch_scc1 L_chk_4
    ds_read_b64 v[2:3], v13 offset:3216
    s_waitcnt lgkmcnt(0)
    v_readfirstlane_b32 s47, v3
    s_nop 0
    s_cmp_eq_u32 s47, 0
    s_cbranch_scc1 L_chk_4
    s_call_b64 s[50:51], L_compute
L_chk_4:
    s_waitcnt vmcnt(9)
    global_load_dwordx4 v[120:123], v14, s[8:9] offset:-2048 nt
    s_cmp_lg_u32 s47, 0
    s_cbranch_scc1 L_chk_5
    ds_read_b64 v[2:3], v13 offset:3216
    s_waitcnt lgkmcnt(0)
    v_readfirstlane_b32 s47, v3
    s_nop 0
    s_cmp_eq_u32 s47, 0
    s_cbranch_scc1 L_chk_5
    s_call_b64 s[50:51], L_compute
L_chk_5:
    s_waitcnt vmcnt(9)
    global_load_dwordx4 v[124:127], v14, s[8:9] offset:-1024 nt
    s_cmp_lg_u32 s47, 0
    s_cbranch_scc1 L_chk_6
    ds_read_b64 v[2:3], v13 offset:3216
    s_waitcnt lgkmcnt(0)
    v_readfirstlane_b32 s47, v3
    s_nop 0
    s_cmp_eq_u32 s47, 0
    s_cbranch_scc1 L_chk_6
    s_call_b64 s[50:51], L_compute
L_chk_6:
    s_waitcnt vmcnt(9)
    global_load_dwordx4 v[128:131], v14, s[8:9] offset:0 nt
    s_cmp_lg_u32 s47, 0
    s_cbranch_scc1 L_chk_7
    ds_read_b64 v[2:3], v13 offset:3216
    s_waitcnt lgkmcnt(0)
    v_readfirstlane_b32 s47, v3
    s_nop 0
    s_cmp_eq_u32 s47, 0
    s_cbranch_scc1 L_chk_7
    s_call_b64 s[50:51], L_compute
L_chk_7:
    s_waitcnt vmcnt(9)
    global_load_dwordx4 v[220:223], v15, s[12:13] offset:0 nt
    s_cmp_lg_u32 s47, 0
    s_cbranch_scc1 L_chk_8
    ds_read_b64 v[2:3], v13 offset:3216
    s_waitcnt lgkmcnt(0)
    v_readfirstlane_b32 s47, v3
    s_nop 0
    s_cmp_eq_u32 s47, 0
    s_cbranch_scc1 L_chk_8
    s_call_b64 s[50:51], L_compute
L_chk_8:
    s_waitcnt vmcnt(9)
    global_load_dwordx4 v[132:135], v14, s[8:9] offset:1024 nt
    s_cmp_lg_u32 s47, 0
    s_cbranch_scc1 L_chk_9
    ds_read_b64 v[2:3], v13 offset:3216
    s_waitcnt lgkmcnt(0)
    v_readfirstlane_b32 s47, v3
    s_nop 0
    s_cmp_eq_u32 s47, 0
    s_cbranch_scc1 L_chk_9
    s_call_b64 s[50:51], L_compute
L_chk_9:
    s_waitcnt vmcnt(9)
    global_load_dwordx4 v[136:139], v14, s[8:9] offset:2048 nt
    s_cmp_lg_u32 s47, 0
    s_cbranch_scc1 L_chk_10
    ds_read_b64 v[2:3], v13 offset:3216
    s_waitcnt lgkmcnt(0)
    v_readfirstlane_b32 s47, v3
    s_nop 0
    s_cmp_eq_u32 s47, 0
    s_cbranch_scc1 L_chk_10
    s_call_b64 s[50:51], L_compute
L_chk_10:
    s_waitcnt vmcnt(9)
    global_load_dwordx4 v[140:143], v14, s[8:9] offset:3072 nt
    s_cmp_lg_u32 s47, 0
    s_cbranch_scc1 L_qw_done_12
    s_mov_b32 s42, 0
L_qw_11:
    ds_read_b64 v[2:3], v13 offset:3216
    s_add_u32 s42, s42, 1
    s_waitcnt lgkmcnt(0)
    v_readfirstlane_b32 s47, v3
    s_nop 0
    s_cmp_lg_u32 s47, 0
    s_cbranch_scc1 L_qw_go_13
    s_cmp_lt_u32 s42, 8000000
    s_cbranch_scc1 L_qw_11
L_qw_go_13:
    s_call_b64 s[50:51], L_compute
L_qw_done_12:
    v_mov_b32_dpp v48, v20 row_newbcast:0 row_mask:0xf bank_mask:0xf
    v_perm_b32 v144, v48, v48, v240
    v_perm_b32 v145, v48, v48, v241
    v_perm_b32 v146, v48, v48, v242
    v_perm_b32 v147, v48, v48, v243
    s_nop 1
    v_mfma_f32_16x16x32_bf16 v[44:47], v[144:147], v[80:83], 0
    v_mov_b32_dpp v49, v20 row_newbcast:4 row_mask:0xf bank_mask:0xf
    v_perm_b32 v148, v49, v49, v240
    v_perm_b32 v149, v49, v49, v241
    v_perm_b32 v150, v49, v49, v242
    v_perm_b32 v151, v49, v49, v243
    s_nop 1
    v_mfma_f32_16x16x32_bf16 v[44:47], v[148:151], v[84:87], v[44:47]
    v_mov_b32_dpp v48, v20 row_newbcast:8 row_mask:0xf bank_mask:0xf
    v_perm_b32 v152, v48, v48, v240
    v_perm_b32 v153, v48, v48, v241
    v_perm_b32 v154, v48, v48, v242
    v_perm_b32 v155, v48, v48, v243
    s_nop 1
    v_mfma_f32_16x16x32_bf16 v[44:47], v[152:155], v[88:91], v[44:47]
    v_mov_b32_dpp v49, v20 row_newbcast:12 row_mask:0xf bank_mask:0xf
    v_perm_b32 v156, v49, v49, v240
    v_perm_b32 v157, v49, v49, v241
    v_perm_b32 v158, v49, v49, v242
    v_perm_b32 v159, v49, v49, v243
    s_nop 1
    v_mfma_f32_16x16x32_bf16 v[44:47], v[156:159], v[92:95], v[44:47]
    v_mov_b32_dpp v48, v21 row_newbcast:0 row_mask:0xf bank_mask:0xf
    v_perm_b32 v144, v48, v48, v240
    v_perm_b32 v145, v48, v48, v241
    v_perm_b32 v146, v48, v48, v242
    v_perm_b32 v147, v48, v48, v243
    s_nop 1
    v_mfma_f32_16x16x32_bf16 v[44:47], v[144:147], v[96:99], v[44:47]
    v_mov_b32_dpp v49, v21 row_newbcast:4 row_mask:0xf bank_mask:0xf
    v_perm_b32 v148, v49, v49, v240
    v_perm_b32 v149, v49, v49, v241
    v_perm_b32 v150, v49, v49, v242
    v_perm_b32 v151, v49, v49, v243
    s_nop 1
    v_mfma_f32_16x16x32_bf16 v[44:47], v[148:151], v[100:103], v[44:47]
    v_mov_b32_dpp v48, v21 row_newbcast:8 row_mask:0xf bank_mask:0xf
    v_perm_b32 v152, v48, v48, v240
    v_perm_b32 v153, v48, v48, v241
    v_perm_b32 v154, v48, v48, v242
    v_perm_b32 v155, v48, v48, v243
    s_nop 1
    v_mfma_f32_16x16x32_bf16 v[44:47], v[152:155], v[104:107], v[44:47]
    v_mov_b32_dpp v49, v21 row_newbcast:12 row_mask:0xf bank_mask:0xf
    v_perm_b32 v156, v49, v49, v240
    v_perm_b32 v157, v49, v49, v241
    v_perm_b32 v158, v49, v49, v242
    v_perm_b32 v159, v49, v49, v243
    s_waitcnt vmcnt(9)
    global_load_dwordx4 v[224:227], v15, s[12:13] offset:1280 nt
    v_mfma_f32_16x16x32_bf16 v[44:47], v[156:159], v[108:111], v[44:47]
    v_mov_b32_dpp v48, v22 row_newbcast:0 row_mask:0xf bank_mask:0xf
    v_perm_b32 v144, v48, v48, v240
    v_perm_b32 v145, v48, v48, v241
    v_perm_b32 v146, v48, v48, v242
    v_perm_b32 v147, v48, v48, v243
    s_waitcnt vmcnt(9)
    global_load_dwordx4 v[228:231], v15, s[12:13] offset:2560 nt
    v_mfma_f32_16x16x32_bf16 v[44:47], v[144:147], v[112:115], v[44:47]
    v_mov_b32_dpp v49, v22 row_newbcast:4 row_mask:0xf bank_mask:0xf
    v_perm_b32 v148, v49, v49, v240
    v_perm_b32 v149, v49, v49, v241
    v_perm_b32 v150, v49, v49, v242
    v_perm_b32 v151, v49, v49, v243
    s_waitcnt vmcnt(9)
    global_load_dwordx4 v[232:235], v15, s[12:13] offset:3840 nt
    v_mfma_f32_16x16x32_bf16 v[44:47], v[148:151], v[116:119], v[44:47]
    v_mov_b32_dpp v48, v22 row_newbcast:8 row_mask:0xf bank_mask:0xf
    v_perm_b32 v152, v48, v48, v240
    v_perm_b32 v153, v48, v48, v241
    v_perm_b32 v154, v48, v48, v242
    v_perm_b32 v155, v48, v48, v243
    s_waitcnt vmcnt(9)
    v_add_u32 v15, 5120, v15
    global_load_dwordx4 v[236:239], v15, s[12:13] offset:0 nt
    v_mfma_f32_16x16x32_bf16 v[44:47], v[152:155], v[120:123], v[44:47]
    v_mov_b32_dpp v49, v22 row_newbcast:12 row_mask:0xf bank_mask:0xf
    v_perm_b32 v156, v49, v49, v240
    v_perm_b32 v157, v49, v49, v241
    v_perm_b32 v158, v49, v49, v242
    v_perm_b32 v159, v49, v49, v243
    s_waitcnt vmcnt(9)
    s_nop 0
    v_mfma_f32_16x16x32_bf16 v[44:47], v[156:159], v[124:127], v[44:47]
    v_mov_b32_dpp v48, v23 row_newbcast:0 row_mask:0xf bank_mask:0xf
    v_perm_b32 v144, v48, v48, v240
    v_perm_b32 v145, v48, v48, v241
    v_perm_b32 v146, v48, v48, v242
    v_perm_b32 v147, v48, v48, v243
    s_waitcnt vmcnt(8)
    s_nop 0
    v_mfma_f32_16x16x32_bf16 v[44:47], v[144:147], v[128:131], v[44:47]
    v_mov_b32_dpp v49, v23 row_newbcast:4 row_mask:0xf bank_mask:0xf
    v_perm_b32 v148, v49, v49, v240
    v_perm_b32 v149, v49, v49, v241
    v_perm_b32 v150, v49, v49, v242
    v_perm_b32 v151, v49, v49, v243
    s_waitcnt vmcnt(6)
    s_nop 0
    v_mfma_f32_16x16x32_bf16 v[44:47], v[148:151], v[132:135], v[44:47]
    v_mov_b32_dpp v48, v23 row_newbcast:8 row_mask:0xf bank_mask:0xf
    v_perm_b32 v152, v48, v48, v240
    v_perm_b32 v153, v48, v48, v241
    v_perm_b32 v154, v48, v48, v242
    v_perm_b32 v155, v48, v48, v243
    s_waitcnt vmcnt(5)
    s_nop 0
    v_mfma_f32_16x16x32_bf16 v[44:47], v[152:155], v[136:139], v[44:47]
    v_mov_b32_dpp v49, v23 row_newbcast:12 row_mask:0xf bank_mask:0xf
    v_perm_b32 v156, v49, v49, v240
    v_perm_b32 v157, v49, v49, v241
    v_perm_b32 v158, v49, v49, v242
    v_perm_b32 v159, v49, v49, v243
    s_waitcnt vmcnt(4)
    s_nop 0
    v_mfma_f32_16x16x32_bf16 v[44:47], v[156:159], v[140:143], v[44:47]
    s_nop 7
    ds_write_b128 v248, v[44:47] offset:4096
    s_waitcnt lgkmcnt(0)
    s_barrier
    s_mov_b32 s52, 0x05040100
    s_mov_b32 s53, 0x07060302
    v_mov_b64 v[64:65], 0
    v_mov_b64 v[66:67], 0
    v_mov_b64 v[68:69], 0
    v_mov_b64 v[70:71], 0
    s_and_b32 s35, s43, 0x1fffffff
    s_and_b32 s67, s35, 0xff
    s_lshr_b32 s36, s35, 8
    s_add_u32 s36, s36, s35
    s_and_b32 s64, s36, 0xff
    s_lshr_b32 s36, s35, 16
    s_add_u32 s36, s36, s35
    s_and_b32 s65, s36, 0xff
    s_lshr_b32 s36, s35, 24
    s_add_u32 s36, s36, s35
    s_and_b32 s66, s36, 0xff
    v_perm_b32 v80, v212, v208, s52
    v_perm_b32 v84, v212, v208, s53
    v_perm_b32 v88, v213, v209, s52
    v_perm_b32 v92, v213, v209, s53
    v_perm_b32 v96, v214, v210, s52
    v_perm_b32 v100, v214, v210, s53
    v_perm_b32 v104, v215, v211, s52
    v_perm_b32 v108, v215, v211, s53
    v_perm_b32 v81, v220, v216, s52
    v_perm_b32 v85, v220, v216, s53
    v_perm_b32 v89, v221, v217, s52
    v_perm_b32 v93, v221, v217, s53
    v_perm_b32 v97, v222, v218, s52
    v_perm_b32 v101, v222, v218, s53
    v_perm_b32 v105, v223, v219, s52
    v_perm_b32 v109, v223, v219, s53
    s_mov_b32 s42, 0
    s_branch L_og_re_15_x
L_og_re_15:
    global_load_dwordx4 v[40:43], v247, s[28:29] sc1
    global_load_dwordx4 v[28:31], v249, s[28:29] sc1
    s_add_u32 s42, s42, 1
    s_cmp_lt_u32 s42, 400000
    s_cbranch_scc1 L_og_14
    s_branch L_og_ok_16
L_og_re_15_x:
    s_barrier
    global_load_dwordx4 v[40:43], v247, s[28:29] sc1
    global_load_dwordx4 v[28:31], v249, s[28:29] sc1
    s_waitcnt vmcnt(4)
    v_perm_b32 v82, v228, v224, s52
    v_perm_b32 v86, v228, v224, s53
    v_perm_b32 v90, v229, v225, s52
    v_perm_b32 v94, v229, v225, s53
    v_perm_b32 v98, v230, v226, s52
    v_perm_b32 v102, v230, v226, s53
    v_perm_b32 v106, v231, v227, s52
    v_perm_b32 v110, v231, v227, s53
    s_waitcnt vmcnt(2)
    v_perm_b32 v83, v236, v232, s52
    v_perm_b32 v87, v236, v232, s53
    v_perm_b32 v91, v237, v233, s52
    v_perm_b32 v95, v237, v233, s53
    v_perm_b32 v99, v238, v234, s52
    v_perm_b32 v103, v238, v234, s53
    v_perm_b32 v107, v239, v235, s52
    v_perm_b32 v111, v239, v235, s53
L_og_14:
    s_waitcnt vmcnt(1)
    v_max_f32_dpp v38, v40, v40 quad_perm:[1,0,3,2] row_mask:0xf bank_mask:0xf
    v_xor_b32 v26, s43, v41
    v_bitop3_b32 v26, v26, v43, s43 bitop3:0xf6
    v_max_f32_dpp v38, v38, v38 quad_perm:[2,3,0,1] row_mask:0xf bank_mask:0xf
    v_and_b32 v26, 0x1fffffff, v26
    v_sub_f32 v38, v40, v38
    v_min_u32 v26, 1, v26
    v_mul_f32 v38, s48, v38
    s_waitcnt vmcnt(0)
    v_exp_f32 v38, v38
    v_xor_b32 v28, s64, v28
    v_xor_b32 v29, s65, v29
    v_xor_b32 v30, s66, v30
    v_xor_b32 v31, s67, v31
    v_mul_f32 v36, v38, v42
    v_or3_b32 v26, v26, v28, v29
    v_pk_mul_f32 v[28:29], v[28:29], v[38:39] op_sel_hi:[1,0]
    v_or3_b32 v26, v26, v30, v31
    v_pk_mul_f32 v[30:31], v[30:31], v[38:39] op_sel_hi:[1,0]
    v_cmp_ne_u32_sdwa vcc, v26, v13 src0_sel:BYTE_0 src1_sel:DWORD
    v_add_f32_dpp v36, v36, v36 quad_perm:[1,0,3,2] row_mask:0xf bank_mask:0xf
    s_cbranch_vccnz L_og_re_15
L_og_ok_16:
    v_add_f32_dpp v28, v28, v28 quad_perm:[1,0,3,2] row_mask:0xf bank_mask:0xf
    v_add_f32_dpp v29, v29, v29 quad_perm:[1,0,3,2] row_mask:0xf bank_mask:0xf
    v_add_f32_dpp v36, v36, v36 quad_perm:[2,3,0,1] row_mask:0xf bank_mask:0xf
    v_add_f32_dpp v30, v30, v30 quad_perm:[1,0,3,2] row_mask:0xf bank_mask:0xf
    v_add_f32_dpp v31, v31, v31 quad_perm:[1,0,3,2] row_mask:0xf bank_mask:0xf
    v_rcp_f32 v36, v36
    v_add_f32_dpp v28, v28, v28 quad_perm:[2,3,0,1] row_mask:0xf bank_mask:0xf
    v_add_f32_dpp v29, v29, v29 quad_perm:[2,3,0,1] row_mask:0xf bank_mask:0xf
    v_add_f32_dpp v30, v30, v30 quad_perm:[2,3,0,1] row_mask:0xf bank_mask:0xf
    v_add_f32_dpp v31, v31, v31 quad_perm:[2,3,0,1] row_mask:0xf bank_mask:0xf
    v_pk_mul_f32 v[28:29], v[28:29], v[36:37] op_sel_hi:[1,0]
    v_pk_mul_f32 v[30:31], v[30:31], v[36:37] op_sel_hi:[1,0]
    v_cvt_pk_bf16_f32 v32, v28, v29
    v_cvt_pk_bf16_f32 v33, v30, v31
    s_nop 0
    v_mov_b32_dpp v64, v32 quad_perm:[0,1,2,3] row_mask:0xf bank_mask:0x5
    v_mov_b32_dpp v66, v32 row_half_mirror row_mask:0xf bank_mask:0x5
    v_mov_b32_dpp v65, v33 quad_perm:[0,1,2,3] row_mask:0xf bank_mask:0x5
    v_mov_b32_dpp v67, v33 row_half_mirror row_mask:0xf bank_mask:0x5
    v_mov_b32_dpp v68, v32 row_half_mirror row_mask:0xf bank_mask:0xa
    v_mov_b32_dpp v69, v33 row_half_mirror row_mask:0xf bank_mask:0xa
    v_mov_b32_dpp v70, v32 quad_perm:[0,1,2,3] row_mask:0xf bank_mask:0xa
    v_mov_b32_dpp v71, v33 quad_perm:[0,1,2,3] row_mask:0xf bank_mask:0xa
    v_mfma_f32_16x16x32_bf16 v[44:47], v[64:67], v[80:83], 0
    v_mfma_f32_16x16x32_bf16 v[48:51], v[64:67], v[84:87], 0
    v_mfma_f32_16x16x32_bf16 v[52:55], v[64:67], v[88:91], 0
    v_mfma_f32_16x16x32_bf16 v[56:59], v[64:67], v[92:95], 0
    v_mfma_f32_16x16x32_bf16 v[44:47], v[68:71], v[96:99], v[44:47]
    v_mfma_f32_16x16x32_bf16 v[48:51], v[68:71], v[100:103], v[48:51]
    v_mfma_f32_16x16x32_bf16 v[52:55], v[68:71], v[104:107], v[52:55]
    v_mfma_f32_16x16x32_bf16 v[56:59], v[68:71], v[108:111], v[56:59]
    s_barrier
    s_nop 4
    v_mov_b32 v45, v48
    v_mov_b32 v46, v52
    v_mov_b32 v47, v56
    ds_write_b128 v248, v[44:47] offset:8192
    s_waitcnt lgkmcnt(0)
    s_barrier
    ds_read2st64_b32 v[28:29], v251 offset0:32 offset1:36
    ds_read2st64_b32 v[30:31], v251 offset0:40 offset1:44
    s_waitcnt lgkmcnt(0)
    v_pk_add_f32 v[28:29], v[28:29], v[30:31]
    v_add_f32 v28, v28, v29
    v_cvt_f64_f32 v[30:31], v28
    v_add_f64 v[30:31], v[30:31], s[60:61]
    global_atomic_add_x2 v250, v[30:31], s[28:29] sc1
    s_cmp_ge_u32 s59, 27
    s_cbranch_scc1 L_nopf_17
    global_load_dword v253, v252, s[20:21]
L_nopf_17:
    s_endpgm
L_att_n:
    s_and_b32 s39, s32, 3
    s_lshl_b32 s39, s39, 3
    s_add_u32 s39, s39, s30
    s_cmp_lt_u32 s39, 27
    s_cselect_b32 s31, 1, 2
    s_min_u32 s39, s39, 26
    s_cmp_lt_u32 s33, 5
    s_cselect_b32 s31, 0, s31
    s_sub_u32 s58, s33, 5
    s_mul_i32 s38, s58, 3
    s_min_u32 s35, s58, 1
    s_add_u32 s38, s38, s35
    s_add_u32 s38, s38, s3
    s_min_u32 s38, s38, 9
    s_mul_i32 s36, s39, 81920
    s_lshl_b32 s37, s38, 7
    s_add_u32 s36, s36, s37
    v_lshrrev_b32 v2, 4, v0
    v_bfe_u32 v3, v0, 3, 1
    v_lshl_add_u32 v4, v3, 2, v2
    v_mul_u32_u24 v4, 10240, v4
    v_and_b32 v5, 7, v0
    v_lshl_add_u32 v4, v5, 4, v4
    v_add_u32 v15, s36, v4
    s_mov_b64 s[44:45], s[20:21]
    s_movk_i32 s46, 1280
    v_lshl_add_u32 v4, v5, 3, v2
    v_lshl_add_u32 v192, v4, 1, s37
    v_mul_u32_u24 v3, 1280, v3
    v_add_u32 v199, v192, v3
    v_bfe_u32 v3, v0, 1, 1
    v_lshl_add_u32 v3, v3, 2, v2
    v_bfe_u32 v4, v0, 2, 2
    v_lshl_add_u32 v198, v3, 2, v4
    s_lshl_b32 s35, s39, 7
    v_lshl_add_u32 v252, v198, 2, s35
    s_mul_i32 s37, s3, 736128
    s_add_u32 s35, s35, s37
    v_mov_b32 v253, s35
    v_mov_b32 v254, s36
    s_and_b32 s35, s3, 1
    s_mul_i32 s35, s35, 1280
    v_lshl_add_u32 v205, v0, 2, s35
    s_lshr_b32 vcc_lo, s31, 1
    s_mov_b32 vcc_hi, 0
    s_waitcnt vmcnt(7)
    global_load_dwordx4 v[60:63], v1, s[6:7] offset:-1024 nt
    ds_write_b32 v12, v247 offset:3264
    s_waitcnt vmcnt(7)
    global_load_dwordx4 v[64:67], v1, s[6:7] offset:0 nt
    s_waitcnt vmcnt(7)
    global_load_dwordx4 v[68:71], v1, s[6:7] offset:1024 nt
    s_waitcnt vmcnt(7)
    global_load_dwordx4 v[72:75], v1, s[6:7] offset:2048 nt
    s_waitcnt vmcnt(7)
    global_load_dwordx4 v[76:79], v1, s[6:7] offset:3072 nt
    s_waitcnt vmcnt(7)
    global_load_dwordx4 v[80:83], v14, s[8:9] offset:-4096 nt
    s_waitcnt vmcnt(7)
    global_load_dwordx4 v[84:87], v14, s[8:9] offset:-3072 nt
    s_waitcnt vmcnt(7)
    global_load_dwordx4 v[88:91], v14, s[8:9] offset:-2048 nt
    s_waitcnt vmcnt(7)
    global_load_dwordx4 v[92:95], v14, s[8:9] offset:-1024 nt
    s_waitcnt vmcnt(7)
    global_load_dwordx4 v[96:99], v14, s[8:9] offset:0 nt
    s_waitcnt vmcnt(7)
    global_load_dwordx4 v[100:103], v14, s[8:9] offset:1024 nt
    s_waitcnt vmcnt(7)
    global_load_dwordx4 v[104:107], v14, s[8:9] offset:2048 nt
    s_waitcnt vmcnt(7)
    global_load_dwordx4 v[108:111], v14, s[8:9] offset:3072 nt
    ds_read_b64 v[2:3], v13 offset:3216
    s_waitcnt lgkmcnt(0)
    v_readfirstlane_b32 s47, v3
    s_nop 0
    s_cmp_eq_u32 s47, 0
    s_cbranch_scc1 L_chk_18
    s_call_b64 s[50:51], L_compute
L_chk_18:
    v_add_u32 v14, 32768, v14
    global_load_dwordx4 v[112:115], v14, s[8:9] offset:-4096 nt
    s_cmp_lg_u32 s47, 0
    s_cbranch_scc1 L_chk_19
    ds_read_b64 v[2:3], v13 offset:3216
    s_waitcnt lgkmcnt(0)
    v_readfirstlane_b32 s47, v3
    s_nop 0
    s_cmp_eq_u32 s47, 0
    s_cbranch_scc1 L_chk_19
    s_call_b64 s[50:51], L_compute
L_chk_19:
    s_waitcnt vmcnt(8)
    global_load_dwordx4 v[116:119], v14, s[8:9] offset:-3072 nt
    s_cmp_lg_u32 s47, 0
    s_cbranch_scc1 L_chk_20
    ds_read_b64 v[2:3], v13 offset:3216
    s_waitcnt lgkmcnt(0)
    v_readfirstlane_b32 s47, v3
    s_nop 0
    s_cmp_eq_u32 s47, 0
    s_cbranch_scc1 L_chk_20
    s_call_b64 s[50:51], L_compute
L_chk_20:
    s_waitcnt vmcnt(8)
    global_load_dwordx4 v[120:123], v14, s[8:9] offset:-2048 nt
    s_cmp_lg_u32 s47, 0
    s_cbranch_scc1 L_chk_21
    ds_read_b64 v[2:3], v13 offset:3216
    s_waitcnt lgkmcnt(0)
    v_readfirstlane_b32 s47, v3
    s_nop 0
    s_cmp_eq_u32 s47, 0
    s_cbranch_scc1 L_chk_21
    s_call_b64 s[50:51], L_compute
L_chk_21:
    s_waitcnt vmcnt(8)
    global_load_dwordx4 v[124:127], v14, s[8:9] offset:-1024 nt
    s_cmp_lg_u32 s47, 0
    s_cbranch_scc1 L_chk_22
    ds_read_b64 v[2:3], v13 offset:3216
    s_waitcnt lgkmcnt(0)
    v_readfirstlane_b32 s47, v3
    s_nop 0
    s_cmp_eq_u32 s47, 0
    s_cbranch_scc1 L_chk_22
    s_call_b64 s[50:51], L_compute
L_chk_22:
    global_load_dword v252, v252, s[18:19]
    s_cmp_lg_u32 s47, 0
    s_cbranch_scc1 L_chk_23
    ds_read_b64 v[2:3], v13 offset:3216
    s_waitcnt lgkmcnt(0)
    v_readfirstlane_b32 s47, v3
    s_nop 0
    s_cmp_eq_u32 s47, 0
    s_cbranch_scc1 L_chk_23
    s_call_b64 s[50:51], L_compute
L_chk_23:
    global_load_dword v253, v253, s[16:17]
    s_cmp_lg_u32 s47, 0
    s_cbranch_scc1 L_chk_24
    ds_read_b64 v[2:3], v13 offset:3216
    s_waitcnt lgkmcnt(0)
    v_readfirstlane_b32 s47, v3
    s_nop 0
    s_cmp_eq_u32 s47, 0
    s_cbranch_scc1 L_chk_24
    s_call_b64 s[50:51], L_compute
L_chk_24:
    global_load_dword v254, v254, s[20:21]
    s_cmp_lg_u32 s47, 0
    s_cbranch_scc1 L_chk_25
    ds_read_b64 v[2:3], v13 offset:3216
    s_waitcnt lgkmcnt(0)
    v_readfirstlane_b32 s47, v3
    s_nop 0
    s_cmp_eq_u32 s47, 0
    s_cbranch_scc1 L_chk_25
    s_call_b64 s[50:51], L_compute
L_chk_25:
    s_waitcnt vmcnt(11)
    global_load_dwordx4 v[128:131], v14, s[8:9] offset:0 nt
    s_cmp_lg_u32 s47, 0
    s_cbranch_scc1 L_chk_26
    ds_read_b64 v[2:3], v13 offset:3216
    s_waitcnt lgkmcnt(0)
    v_readfirstlane_b32 s47, v3
    s_nop 0
    s_cmp_eq_u32 s47, 0
    s_cbranch_scc1 L_chk_26
    s_call_b64 s[50:51], L_compute
L_chk_26:
    s_waitcnt vmcnt(11)
    global_load_dwordx4 v[132:135], v14, s[8:9] offset:1024 nt
    s_cmp_lg_u32 s47, 0
    s_cbranch_scc1 L_chk_27
    ds_read_b64 v[2:3], v13 offset:3216
    s_waitcnt lgkmcnt(0)
    v_readfirstlane_b32 s47, v3
    s_nop 0
    s_cmp_eq_u32 s47, 0
    s_cbranch_scc1 L_chk_27
    s_call_b64 s[50:51], L_compute
L_chk_27:
    global_load_ushort v193, v192, s[22:23] offset:8
    s_cmp_lg_u32 s47, 0
    s_cbranch_scc1 L_chk_28
    ds_read_b64 v[2:3], v13 offset:3216
    s_waitcnt lgkmcnt(0)
    v_readfirstlane_b32 s47, v3
    s_nop 0
    s_cmp_eq_u32 s47, 0
    s_cbranch_scc1 L_chk_28
    s_call_b64 s[50:51], L_compute
L_chk_28:
    global_load_ushort v192, v192, s[22:23]
    s_cmp_lg_u32 s47, 0
    s_cbranch_scc1 L_chk_29
    ds_read_b64 v[2:3], v13 offset:3216
    s_waitcnt lgkmcnt(0)
    v_readfirstlane_b32 s47, v3
    s_nop 0
    s_cmp_eq_u32 s47, 0
    s_cbranch_scc1 L_chk_29
    s_call_b64 s[50:51], L_compute
L_chk_29:
    global_load_ushort v206, v199, s[24:25]
    s_cmp_lg_u32 s47, 0
    s_cbranch_scc1 L_chk_30
    ds_read_b64 v[2:3], v13 offset:3216
    s_waitcnt lgkmcnt(0)
    v_readfirstlane_b32 s47, v3
    s_nop 0
    s_cmp_eq_u32 s47, 0
    s_cbranch_scc1 L_chk_30
    s_call_b64 s[50:51], L_compute
L_chk_30:
    s_waitcnt vmcnt(14)
    global_load_dwordx4 v[136:139], v14, s[8:9] offset:2048 nt
    s_cmp_lg_u32 s47, 0
    s_cbranch_scc1 L_chk_31
    ds_read_b64 v[2:3], v13 offset:3216
    s_waitcnt lgkmcnt(0)
    v_readfirstlane_b32 s47, v3
    s_nop 0
    s_cmp_eq_u32 s47, 0
    s_cbranch_scc1 L_chk_31
    s_call_b64 s[50:51], L_compute
L_chk_31:
    s_waitcnt vmcnt(14)
    global_load_dwordx4 v[140:143], v14, s[8:9] offset:3072 nt
    s_cmp_lg_u32 s47, 0
    s_cbranch_scc1 L_qw_done_33
    s_mov_b32 s42, 0
L_qw_32:
    ds_read_b64 v[2:3], v13 offset:3216
    s_add_u32 s42, s42, 1
    s_waitcnt lgkmcnt(0)
    v_readfirstlane_b32 s47, v3
    s_nop 0
    s_cmp_lg_u32 s47, 0
    s_cbranch_scc1 L_qw_go_34
    s_cmp_lt_u32 s42, 8000000
    s_cbranch_scc1 L_qw_32
L_qw_go_34:
    s_call_b64 s[50:51], L_compute
L_qw_done_33:
    global_load_dword v176, v205, s[4:5] offset:0
    global_load_dword v177, v205, s[4:5] offset:256
    global_load_dword v178, v205, s[4:5] offset:512
    global_load_dword v179, v205, s[4:5] offset:768
    global_load_dword v180, v205, s[4:5] offset:1024
    v_mov_b32_dpp v48, v20 row_newbcast:0 row_mask:0xf bank_mask:0xf
    v_perm_b32 v144, v48, v48, v240
    v_perm_b32 v145, v48, v48, v241
    v_perm_b32 v146, v48, v48, v242
    v_perm_b32 v147, v48, v48, v243
    s_nop 1
    v_mfma_f32_16x16x32_bf16 v[44:47], v[144:147], v[80:83], 0
    v_mov_b32_dpp v49, v20 row_newbcast:4 row_mask:0xf bank_mask:0xf
    v_perm_b32 v148, v49, v49, v240
    v_perm_b32 v149, v49, v49, v241
    v_perm_b32 v150, v49, v49, v242
    v_perm_b32 v151, v49, v49, v243
    s_nop 1
    v_mfma_f32_16x16x32_bf16 v[44:47], v[148:151], v[84:87], v[44:47]
    v_mov_b32_dpp v48, v20 row_newbcast:8 row_mask:0xf bank_mask:0xf
    v_perm_b32 v152, v48, v48, v240
    v_perm_b32 v153, v48, v48, v241
    v_perm_b32 v154, v48, v48, v242
    v_perm_b32 v155, v48, v48, v243
    s_nop 1
    v_mfma_f32_16x16x32_bf16 v[44:47], v[152:155], v[88:91], v[44:47]
    v_mov_b32_dpp v49, v20 row_newbcast:12 row_mask:0xf bank_mask:0xf
    v_perm_b32 v156, v49, v49, v240
    v_perm_b32 v157, v49, v49, v241
    v_perm_b32 v158, v49, v49, v242
    v_perm_b32 v159, v49, v49, v243
    s_nop 1
    v_mfma_f32_16x16x32_bf16 v[44:47], v[156:159], v[92:95], v[44:47]
    v_mov_b32_dpp v48, v21 row_newbcast:0 row_mask:0xf bank_mask:0xf
    v_perm_b32 v144, v48, v48, v240
    v_perm_b32 v145, v48, v48, v241
    v_perm_b32 v146, v48, v48, v242
    v_perm_b32 v147, v48, v48, v243
    s_nop 1
    v_mfma_f32_16x16x32_bf16 v[44:47], v[144:147], v[96:99], v[44:47]
    v_mov_b32_dpp v49, v21 row_newbcast:4 row_mask:0xf bank_mask:0xf
    v_perm_b32 v148, v49, v49, v240
    v_perm_b32 v149, v49, v49, v241
    v_perm_b32 v150, v49, v49, v242
    v_perm_b32 v151, v49, v49, v243
    s_nop 1
    v_mfma_f32_16x16x32_bf16 v[44:47], v[148:151], v[100:103], v[44:47]
    v_mov_b32_dpp v48, v21 row_newbcast:8 row_mask:0xf bank_mask:0xf
    v_perm_b32 v152, v48, v48, v240
    v_perm_b32 v153, v48, v48, v241
    v_perm_b32 v154, v48, v48, v242
    v_perm_b32 v155, v48, v48, v243
    s_nop 1
    v_mfma_f32_16x16x32_bf16 v[44:47], v[152:155], v[104:107], v[44:47]
    v_mov_b32_dpp v49, v21 row_newbcast:12 row_mask:0xf bank_mask:0xf
    v_perm_b32 v156, v49, v49, v240
    v_perm_b32 v157, v49, v49, v241
    v_perm_b32 v158, v49, v49, v242
    v_perm_b32 v159, v49, v49, v243
    s_waitcnt vmcnt(19)
    s_nop 0
    v_mfma_f32_16x16x32_bf16 v[44:47], v[156:159], v[108:111], v[44:47]
    v_mov_b32_dpp v48, v22 row_newbcast:0 row_mask:0xf bank_mask:0xf
    v_perm_b32 v144, v48, v48, v240
    v_perm_b32 v145, v48, v48, v241
    v_perm_b32 v146, v48, v48, v242
    v_perm_b32 v147, v48, v48, v243
    s_waitcnt vmcnt(18)
    s_nop 0
    v_mfma_f32_16x16x32_bf16 v[44:47], v[144:147], v[112:115], v[44:47]
    v_mov_b32_dpp v49, v22 row_newbcast:4 row_mask:0xf bank_mask:0xf
    v_perm_b32 v148, v49, v49, v240
    v_perm_b32 v149, v49, v49, v241
    v_perm_b32 v150, v49, v49, v242
    v_perm_b32 v151, v49, v49, v243
    s_waitcnt vmcnt(17)
    s_nop 0
    v_mfma_f32_16x16x32_bf16 v[44:47], v[148:151], v[116:119], v[44:47]
    v_mov_b32_dpp v48, v22 row_newbcast:8 row_mask:0xf bank_mask:0xf
    v_perm_b32 v152, v48, v48, v240
    v_perm_b32 v153, v48, v48, v241
    v_perm_b32 v154, v48, v48, v242
    v_perm_b32 v155, v48, v48, v243
    s_waitcnt vmcnt(16)
    s_nop 0
    v_mfma_f32_16x16x32_bf16 v[44:47], v[152:155], v[120:123], v[44:47]
    v_mov_b32_dpp v49, v22 row_newbcast:12 row_mask:0xf bank_mask:0xf
    v_perm_b32 v156, v49, v49, v240
    v_perm_b32 v157, v49, v49, v241
    v_perm_b32 v158, v49, v49, v242
    v_perm_b32 v159, v49, v49, v243
    s_waitcnt vmcnt(15)
    s_nop 0
    v_mfma_f32_16x16x32_bf16 v[44:47], v[156:159], v[124:127], v[44:47]
    v_mov_b32_dpp v48, v23 row_newbcast:0 row_mask:0xf bank_mask:0xf
    v_perm_b32 v144, v48, v48, v240
    v_perm_b32 v145, v48, v48, v241
    v_perm_b32 v146, v48, v48, v242
    v_perm_b32 v147, v48, v48, v243
    s_waitcnt vmcnt(11)
    s_nop 0
    v_mfma_f32_16x16x32_bf16 v[44:47], v[144:147], v[128:131], v[44:47]
    v_mov_b32_dpp v49, v23 row_newbcast:4 row_mask:0xf bank_mask:0xf
    v_perm_b32 v148, v49, v49, v240
    v_perm_b32 v149, v49, v49, v241
    v_perm_b32 v150, v49, v49, v242
    v_perm_b32 v151, v49, v49, v243
    s_waitcnt vmcnt(10)
    s_nop 0
    v_mfma_f32_16x16x32_bf16 v[44:47], v[148:151], v[132:135], v[44:47]
    v_mov_b32_dpp v48, v23 row_newbcast:8 row_mask:0xf bank_mask:0xf
    v_perm_b32 v152, v48, v48, v240
    v_perm_b32 v153, v48, v48, v241
    v_perm_b32 v154, v48, v48, v242
    v_perm_b32 v155, v48, v48, v243
    s_waitcnt vmcnt(6)
    s_nop 0
    v_mfma_f32_16x16x32_bf16 v[44:47], v[152:155], v[136:139], v[44:47]
    v_mov_b32_dpp v49, v23 row_newbcast:12 row_mask:0xf bank_mask:0xf
    v_perm_b32 v156, v49, v49, v240
    v_perm_b32 v157, v49, v49, v241
    v_perm_b32 v158, v49, v49, v242
    v_perm_b32 v159, v49, v49, v243
    s_waitcnt vmcnt(5)
    s_nop 0
    v_mfma_f32_16x16x32_bf16 v[44:47], v[156:159], v[140:143], v[44:47]
    s_nop 7
    ds_write_b128 v248, v[44:47] offset:4096
    s_waitcnt lgkmcnt(0)
    s_barrier
    s_cmp_eq_u32 s31, 1
    s_cbranch_scc1 L_mlp_go_35
    s_endpgm
L_mlp_go_35:
    v_lshrrev_b32 v2, 3, v0
    v_and_b32 v3, 2, v2
    v_and_b32 v4, 7, v0
    v_xor_b32 v3, v3, v4
    v_mul_u32_u24 v2, 3456, v2
    s_mul_i32 s35, s3, 552960
    s_lshl_b32 s36, s39, 7
    s_add_u32 s35, s35, s36
    v_lshl_add_u32 v16, v3, 4, v2
    v_add_u32 v16, s35, v16
    v_xor_b32 v3, 4, v3
    v_lshl_add_u32 v17, v3, 4, v2
    s_add_u32 s35, s35, 27648
    v_add_u32 v17, s35, v17
    s_mul_i32 s37, s3, 20480
    s_add_u32 s37, s37, 16384
    s_mul_i32 s54, s58, 3
    s_mov_b32 s57, 10
    s_barrier
L_dma_36:
    s_mul_i32 s55, s54, 55296
    s_lshl_b32 s56, s54, 11
    s_add_u32 s56, s56, s37
    s_mov_b32 m0, s56
    v_add_u32 v2, s55, v16
    v_add_u32 v3, s55, v17
    global_load_lds_dwordx4 v2, s[16:17]
    s_add_u32 m0, s56, 1024
    s_add_u32 s54, s54, 1
    global_load_lds_dwordx4 v3, s[16:17]
    s_cmp_eq_u32 s54, 10
    s_cselect_b32 s54, 0, s54
    s_sub_u32 s57, s57, 1
    s_cmp_lg_u32 s57, 0
    s_cbranch_scc1 L_dma_36
L_dma_36_x:
    v_lshrrev_b32 v2, 4, v0
    v_and_b32 v12, 15, v0
    v_and_b32 v3, 1, v0
    v_lshlrev_b32 v21, 3, v0
    v_and_b32 v4, 16, v0
    v_xor_b32 v21, v21, v4
    s_lshl_b32 s35, s3, 9
    s_add_u32 s35, s35, 12288
    v_bfe_u32 v4, v0, 1, 4
    v_lshl_add_u32 v22, v4, 5, s35
    v_lshl_add_u32 v22, v3, 2, v22
    v_lshrrev_b32 v4, 2, v0
    v_xor_b32 v4, v4, v0
    v_and_b32 v4, 8, v4
    v_lshl_add_u32 v22, v4, 1, v22
    s_mul_i32 s35, s3, 160
    v_mul_u32_u24 v4, 1408, v3
    v_lshl_add_u32 v4, v2, 4, v4
    v_add_u32 v23, s35, v4
    v_bfe_u32 v4, v0, 2, 2
    v_lshl_add_u32 v4, v2, 3, v4
    v_lshlrev_b32 v4, 7, v4
    v_lshl_add_u32 v4, v3, 3, v4
    v_add_u32 v4, s37, v4
    v_bfe_u32 v3, v0, 3, 2
    v_bfe_u32 v5, v0, 1, 1
    v_lshl_add_u32 v3, v3, 1, v5
    v_xor_b32 v5, 0, v3
    v_lshl_add_u32 v16, v5, 4, v4
    v_xor_b32 v5, 2, v3
    v_lshl_add_u32 v17, v5, 4, v4
    v_xor_b32 v5, 4, v3
    v_lshl_add_u32 v18, v5, 4, v4
    v_xor_b32 v5, 6, v3
    v_lshl_add_u32 v19, v5, 4, v4
    s_lshl_b32 s35, s38, 11
    s_add_u32 s35, s35, 20480
    v_and_b32 v3, 56, v0
    v_lshlrev_b32 v3, 3, v3
    v_lshl_add_u32 v3, v0, 3, v3
    v_add_u32 v25, s35, v3
    s_and_b32 s36, s3, 1
    s_mul_i32 s35, s36, 5120
    s_add_u32 s35, s35, 2048
    v_lshl_add_u32 v2, v0, 4, s35
    s_mul_i32 s35, s36, 1408
    v_lshl_add_u32 v26, v0, 2, s35
    v_lshrrev_b32 v3, 1, v0
    v_lshl_add_u32 v26, v3, 2, s35
    v_and_b32 v3, 1, v0
    v_mul_u32_u24 v3, 704, v3
    v_add_u32 v26, v26, v3
    v_bfe_u32 v3, v0, 1, 1
    v_mul_u32_u24 v4, 704, v3
    v_add_u32 v23, v23, v4
    v_mul_u32_u24 v3, 0xaaaa, v3
    v_add_u32 v204, 0x4444, v3
    v_add_u32 v3, 96, v23
    v_mov_b32 v4, 3200
    v_cmp_gt_u32 vcc, 32, v0
    s_nop 1
    v_cndmask_b32 v24, v3, v4, vcc
    s_mul_i32 s35, s36, 2560
    s_cmp_ge_u32 s3, 2
    s_cmov_b32 s35, 16384
    v_lshl_add_u32 v27, v0, 3, s35
    v_lshlrev_b32 v197, 1, v199
    v_add_u32 v197, 4096, v197
    v_and_b32 v195, 0xffff0000, v252
    v_lshlrev_b32 v194, 16, v252
    v_lshlrev_b32 v192, 16, v192
    v_lshlrev_b32 v193, 16, v193
    v_mov_b32 v201, 0xc0135761
    v_mov_b32 v200, 0xbdd2d3e8
    s_mov_b32 s60, 0
    s_mov_b32 s61, 1096286208
    s_mov_b32 s62, 0x4a000000
    s_mov_b32 s63, 0x53800000
    s_cmp_lt_u32 s3, 2
    s_cselect_b64 s[70:71], -1, 0
    s_mov_b32 s52, 0x05040100
    s_mov_b32 s53, 0x07060302
    v_mov_b64 v[64:65], 0
    v_mov_b64 v[66:67], 0
    v_mov_b64 v[68:69], 0
    v_mov_b64 v[70:71], 0
    v_mov_b64 v[72:73], 0
    v_mov_b64 v[74:75], 0
    v_mov_b64 v[76:77], 0
    v_mov_b64 v[78:79], 0
    v_lshlrev_b32 v4, 16, v176
    v_and_b32 v5, 0xffff0000, v176
    v_lshlrev_b32 v6, 16, v177
    v_and_b32 v7, 0xffff0000, v177
    v_lshlrev_b32 v8, 16, v178
    v_and_b32 v9, 0xffff0000, v178
    v_lshlrev_b32 v10, 16, v179
    v_and_b32 v11, 0xffff0000, v179
    v_lshlrev_b32 v62, 16, v180
    v_and_b32 v63, 0xffff0000, v180
    v_mov_b64 v[50:51], 0
    v_mov_b64 v[52:53], 0
    v_mov_b64 v[54:55], 0
    v_mov_b64 v[56:57], 0
    v_mov_b64 v[58:59], 0
    v_mov_b64 v[60:61], 0
    v_mov_b64 v[240:241], 0
    v_mov_b64 v[242:243], 0
    s_mov_b32 s42, 0
    s_branch L_acc_38_x
L_acc_38:
    global_load_dwordx4 v[160:163], v2, s[28:29] offset:-2048 sc1
    global_load_dwordx4 v[164:167], v2, s[28:29] offset:-1024 sc1
    global_load_dwordx4 v[168:171], v2, s[28:29] offset:0 sc1
    global_load_dwordx4 v[172:175], v2, s[28:29] offset:1024 sc1
    global_load_dwordx4 v[176:179], v2, s[28:29] offset:2048 sc1
    s_add_u32 s42, s42, 1
    s_cmp_lt_u32 s42, 400000
    s_waitcnt vmcnt(0)
    s_cbranch_scc1 L_acc_w_40
    s_branch L_acc_ok_39
L_acc_38_x:
    s_cmp_ge_u32 s3, 2
    s_barrier
    s_cbranch_scc1 L_noln2_41
    global_load_dwordx4 v[160:163], v2, s[28:29] offset:-2048 sc1
    global_load_dwordx4 v[164:167], v2, s[28:29] offset:-1024 sc1
    global_load_dwordx4 v[168:171], v2, s[28:29] offset:0 sc1
    global_load_dwordx4 v[172:175], v2, s[28:29] offset:1024 sc1
    global_load_dwordx4 v[176:179], v2, s[28:29] offset:2048 sc1
    s_waitcnt vmcnt(5)
    ds_read_b64_tr_b16 v[80:81], v16 offset:0
    ds_read_b64_tr_b16 v[82:83], v16 offset:512
    ds_read_b64_tr_b16 v[100:101], v17 offset:0
    ds_read_b64_tr_b16 v[102:103], v17 offset:512
    ds_read_b64_tr_b16 v[120:121], v18 offset:0
    ds_read_b64_tr_b16 v[122:123], v18 offset:512
    ds_read_b64_tr_b16 v[140:141], v19 offset:0
    ds_read_b64_tr_b16 v[142:143], v19 offset:512
    ds_read_b64_tr_b16 v[84:85], v16 offset:4096
    ds_read_b64_tr_b16 v[86:87], v16 offset:4608
    ds_read_b64_tr_b16 v[104:105], v17 offset:4096
    ds_read_b64_tr_b16 v[106:107], v17 offset:4608
    ds_read_b64_tr_b16 v[124:125], v18 offset:4096
    ds_read_b64_tr_b16 v[126:127], v18 offset:4608
    ds_read_b64_tr_b16 v[144:145], v19 offset:4096
    ds_read_b64_tr_b16 v[146:147], v19 offset:4608
    ds_read_b64_tr_b16 v[88:89], v16 offset:8192
    ds_read_b64_tr_b16 v[90:91], v16 offset:8704
    ds_read_b64_tr_b16 v[108:109], v17 offset:8192
    ds_read_b64_tr_b16 v[110:111], v17 offset:8704
    ds_read_b64_tr_b16 v[128:129], v18 offset:8192
    ds_read_b64_tr_b16 v[130:131], v18 offset:8704
    ds_read_b64_tr_b16 v[148:149], v19 offset:8192
    ds_read_b64_tr_b16 v[150:151], v19 offset:8704
    ds_read_b64_tr_b16 v[92:93], v16 offset:12288
    ds_read_b64_tr_b16 v[94:95], v16 offset:12800
    ds_read_b64_tr_b16 v[112:113], v17 offset:12288
    ds_read_b64_tr_b16 v[114:115], v17 offset:12800
    ds_read_b64_tr_b16 v[132:133], v18 offset:12288
    ds_read_b64_tr_b16 v[134:135], v18 offset:12800
    ds_read_b64_tr_b16 v[152:153], v19 offset:12288
    ds_read_b64_tr_b16 v[154:155], v19 offset:12800
    ds_read_b64_tr_b16 v[96:97], v16 offset:16384
    ds_read_b64_tr_b16 v[98:99], v16 offset:16896
    ds_read_b64_tr_b16 v[116:117], v17 offset:16384
    ds_read_b64_tr_b16 v[118:119], v17 offset:16896
    ds_read_b64_tr_b16 v[136:137], v18 offset:16384
    ds_read_b64_tr_b16 v[138:139], v18 offset:16896
    ds_read_b64_tr_b16 v[156:157], v19 offset:16384
    ds_read_b64_tr_b16 v[158:159], v19 offset:16896
    global_load_dwordx4 v[208:211], v15, s[44:45]
    v_add_u32 v15, s46, v15
    global_load_dwordx4 v[212:215], v15, s[44:45]
    v_add_u32 v15, s46, v15
    global_load_dwordx4 v[216:219], v15, s[44:45]
    v_add_u32 v15, s46, v15
    global_load_dwordx4 v[220:223], v15, s[44:45]
    v_add_u32 v15, s46, v15
    global_load_dwordx4 v[224:227], v15, s[44:45]
    v_add_u32 v15, s46, v15
    global_load_dwordx4 v[228:231], v15, s[44:45]
    v_add_u32 v15, s46, v15
    global_load_dwordx4 v[232:235], v15, s[44:45]
    v_add_u32 v15, s46, v15
    global_load_dwordx4 v[236:239], v15, s[44:45]
L_acc_w_40:
L_dry_in:
    s_waitcnt vmcnt(12)
    v_add_f64 v[160:161], v[160:161], -s[60:61]
    v_add_f64 v[162:163], v[162:163], -s[60:61]
    v_cvt_f32_f64 v28, v[160:161]
    v_cvt_f32_f64 v29, v[162:163]
    v_cvt_pk_bf16_f32 v28, 0, v28
    v_cvt_pk_bf16_f32 v29, 0, v29
    v_pk_add_f32 v[28:29], v[28:29], v[4:5]
    v_cvt_pk_bf16_f32 v244, 0, v28
    v_cvt_pk_bf16_f32 v245, 0, v29
    v_pk_mul_f32 v[48:49], v[244:245], v[244:245]
    s_waitcnt vmcnt(11)
    v_add_f64 v[164:165], v[164:165], -s[60:61]
    v_add_f64 v[166:167], v[166:167], -s[60:61]
    v_cvt_f32_f64 v30, v[164:165]
    v_cvt_f32_f64 v31, v[166:167]
    v_cvt_pk_bf16_f32 v30, 0, v30
    v_cvt_pk_bf16_f32 v31, 0, v31
    v_pk_add_f32 v[30:31], v[30:31], v[6:7]
    v_cvt_pk_bf16_f32 v246, 0, v30
    v_cvt_pk_bf16_f32 v247, 0, v31
    v_pk_fma_f32 v[48:49], v[246:247], v[246:247], v[48:49]
    v_pk_add_f32 v[46:47], v[246:247], v[244:245]
    s_waitcnt vmcnt(10)
    v_add_f64 v[168:169], v[168:169], -s[60:61]
    v_add_f64 v[170:171], v[170:171], -s[60:61]
    v_cvt_f32_f64 v32, v[168:169]
    v_cvt_f32_f64 v33, v[170:171]
    v_cvt_pk_bf16_f32 v32, 0, v32
    v_cvt_pk_bf16_f32 v33, 0, v33
    v_pk_add_f32 v[32:33], v[32:33], v[8:9]
    v_cvt_pk_bf16_f32 v248, 0, v32
    v_cvt_pk_bf16_f32 v249, 0, v33
    v_pk_fma_f32 v[48:49], v[248:249], v[248:249], v[48:49]
    v_pk_add_f32 v[46:47], v[248:249], v[46:47]
    s_waitcnt vmcnt(9)
    v_add_f64 v[172:173], v[172:173], -s[60:61]
    v_add_f64 v[174:175], v[174:175], -s[60:61]
    v_cvt_f32_f64 v34, v[172:173]
    v_cvt_f32_f64 v35, v[174:175]
    v_cvt_pk_bf16_f32 v34, 0, v34
    v_cvt_pk_bf16_f32 v35, 0, v35
    v_pk_add_f32 v[34:35], v[34:35], v[10:11]
    v_cvt_pk_bf16_f32 v250, 0, v34
    v_cvt_pk_bf16_f32 v251, 0, v35
    v_pk_fma_f32 v[48:49], v[250:251], v[250:251], v[48:49]
    v_pk_add_f32 v[46:47], v[250:251], v[46:47]
    s_waitcnt vmcnt(8)
    v_add_f64 v[176:177], v[176:177], -s[60:61]
    v_add_f64 v[178:179], v[178:179], -s[60:61]
    v_cvt_f32_f64 v36, v[176:177]
    v_cvt_f32_f64 v37, v[178:179]
    v_cvt_pk_bf16_f32 v36, 0, v36
    v_cvt_pk_bf16_f32 v37, 0, v37
    v_pk_add_f32 v[36:37], v[36:37], v[62:63]
    v_cvt_pk_bf16_f32 v252, 0, v36
    v_cvt_pk_bf16_f32 v253, 0, v37
    v_pk_fma_f32 v[48:49], v[252:253], v[252:253], v[48:49]
    v_pk_add_f32 v[46:47], v[252:253], v[46:47]
    v_add_f32 v48, v48, v49
    v_add_f32 v46, v46, v47
    v_cmp_ngt_f32 vcc, s63, v48
    s_cbranch_vccnz L_acc_38
L_acc_ok_39:
    v_permlane32_swap_b32 v46, v48
    v_add_f32 v46, v46, v48
    s_nop 1
    v_add_f32_dpp v46, v46, v46 quad_perm:[1,0,3,2] row_mask:0xf bank_mask:0xf
    s_nop 1
    v_add_f32_dpp v46, v46, v46 quad_perm:[2,3,0,1] row_mask:0xf bank_mask:0xf
    s_nop 1
    v_add_f32_dpp v46, v46, v46 row_half_mirror row_mask:0xf bank_mask:0xf
    s_nop 1
    v_add_f32_dpp v46, v46, v46 row_mirror row_mask:0xf bank_mask:0xf
    s_nop 1
    v_add_f32_dpp v46, v46, v46 row_bcast:15 row_mask:0xa bank_mask:0xf
    v_mul_f32 v46, 0x3acccccd, v46
    s_nop 0
    v_readlane_b32 s41, v46, 63
    v_readlane_b32 s40, v46, 31
    s_nop 0
    v_mov_b32 v48, s41
    v_cvt_pk_bf16_f32 v46, 0, s40
    v_fma_f32 v48, -s40, s40, v48
    v_pk_add_f32 v[28:29], v[244:245], v[46:47] op_sel_hi:[1,0] neg_lo:[0,1] neg_hi:[0,1]
    v_max_f32 v48, 0, v48
    v_pk_add_f32 v[30:31], v[246:247], v[46:47] op_sel_hi:[1,0] neg_lo:[0,1] neg_hi:[0,1]
    v_cvt_pk_bf16_f32 v48, 0, v48
    v_pk_add_f32 v[32:33], v[248:249], v[46:47] op_sel_hi:[1,0] neg_lo:[0,1] neg_hi:[0,1]
    v_add_f32 v48, 0x3727c5ac, v48
    v_pk_add_f32 v[34:35], v[250:251], v[46:47] op_sel_hi:[1,0] neg_lo:[0,1] neg_hi:[0,1]
    v_cvt_pk_bf16_f32 v48, 0, v48
    v_pk_add_f32 v[36:37], v[252:253], v[46:47] op_sel_hi:[1,0] neg_lo:[0,1] neg_hi:[0,1]
    v_sqrt_f32 v48, v48
    v_cvt_pk_bf16_f32 v28, 0, v28
    v_cvt_pk_bf16_f32 v29, 0, v29
    v_cvt_pk_bf16_f32 v48, 0, v48
    v_cvt_pk_bf16_f32 v30, 0, v30
    v_rcp_f32 v48, v48
    v_cvt_pk_bf16_f32 v31, 0, v31
    v_cvt_pk_bf16_f32 v32, 0, v32
    v_cvt_pk_bf16_f32 v33, 0, v33
    v_cvt_pk_bf16_f32 v34, 0, v34
    v_cvt_pk_bf16_f32 v35, 0, v35
    v_cvt_pk_bf16_f32 v36, 0, v36
    v_cvt_pk_bf16_f32 v37, 0, v37
    v_pk_mul_f32 v[28:29], v[28:29], v[48:49] op_sel_hi:[1,0]
    v_pk_mul_f32 v[30:31], v[30:31], v[48:49] op_sel_hi:[1,0]
    v_pk_mul_f32 v[32:33], v[32:33], v[48:49] op_sel_hi:[1,0]
    v_pk_mul_f32 v[34:35], v[34:35], v[48:49] op_sel_hi:[1,0]
    v_pk_mul_f32 v[36:37], v[36:37], v[48:49] op_sel_hi:[1,0]
    v_cvt_pk_bf16_f32 v28, 0, v28
    v_cvt_pk_bf16_f32 v29, 0, v29
    v_cvt_pk_bf16_f32 v30, 0, v30
    v_cvt_pk_bf16_f32 v31, 0, v31
    v_cvt_pk_bf16_f32 v32, 0, v32
    v_cvt_pk_bf16_f32 v33, 0, v33
    v_cvt_pk_bf16_f32 v34, 0, v34
    v_cvt_pk_bf16_f32 v35, 0, v35
    v_cvt_pk_bf16_f32 v36, 0, v36
    v_cvt_pk_bf16_f32 v37, 0, v37
    v_pk_add_f32 v[46:47], v[28:29], v[30:31]
    v_pk_mul_f32 v[48:49], v[28:29], v[28:29]
    v_pk_add_f32 v[46:47], v[46:47], v[32:33]
    v_pk_fma_f32 v[48:49], v[30:31], v[30:31], v[48:49]
    v_pk_add_f32 v[46:47], v[46:47], v[34:35]
    v_pk_fma_f32 v[48:49], v[32:33], v[32:33], v[48:49]
    v_pk_add_f32 v[46:47], v[46:47], v[36:37]
    v_pk_fma_f32 v[48:49], v[34:35], v[34:35], v[48:49]
    v_pk_fma_f32 v[48:49], v[36:37], v[36:37], v[48:49]
    v_add_f32 v48, v48, v49
    v_add_f32 v46, v46, v47
    s_nop 1
    v_permlane32_swap_b32 v46, v48
    v_add_f32 v46, v46, v48
    s_nop 1
    v_add_f32_dpp v46, v46, v46 quad_perm:[1,0,3,2] row_mask:0xf bank_mask:0xf
    s_nop 1
    v_add_f32_dpp v46, v46, v46 quad_perm:[2,3,0,1] row_mask:0xf bank_mask:0xf
    s_nop 1
    v_add_f32_dpp v46, v46, v46 row_half_mirror row_mask:0xf bank_mask:0xf
    s_nop 1
    v_add_f32_dpp v46, v46, v46 row_mirror row_mask:0xf bank_mask:0xf
    s_nop 1
    v_add_f32_dpp v46, v46, v46 row_bcast:15 row_mask:0xa bank_mask:0xf
    v_mul_f32 v46, 0x3acccccd, v46
    s_nop 0
    v_readlane_b32 s41, v46, 63
    v_readlane_b32 s40, v46, 31
    s_nop 0
    v_mov_b32 v48, s41
    v_cvt_pk_bf16_f32 v46, 0, s40
    v_fma_f32 v48, -s40, s40, v48
    v_pk_add_f32 v[28:29], v[28:29], v[46:47] op_sel_hi:[1,0] neg_lo:[0,1] neg_hi:[0,1]
    v_max_f32 v48, 0, v48
    v_pk_add_f32 v[30:31], v[30:31], v[46:47] op_sel_hi:[1,0] neg_lo:[0,1] neg_hi:[0,1]
    v_cvt_pk_bf16_f32 v48, 0, v48
    v_pk_add_f32 v[32:33], v[32:33], v[46:47] op_sel_hi:[1,0] neg_lo:[0,1] neg_hi:[0,1]
    v_add_f32 v48, 0x3727c5ac, v48
    v_pk_add_f32 v[34:35], v[34:35], v[46:47] op_sel_hi:[1,0] neg_lo:[0,1] neg_hi:[0,1]
    v_cvt_pk_bf16_f32 v48, 0, v48
    v_pk_add_f32 v[36:37], v[36:37], v[46:47] op_sel_hi:[1,0] neg_lo:[0,1] neg_hi:[0,1]
    v_sqrt_f32 v48, v48
    v_cvt_pk_bf16_f32 v28, 0, v28
    v_cvt_pk_bf16_f32 v29, 0, v29
    v_cvt_pk_bf16_f32 v48, 0, v48
    v_cvt_pk_bf16_f32 v30, 0, v30
    v_rcp_f32 v48, v48
    v_cvt_pk_bf16_f32 v31, 0, v31
    v_cvt_pk_bf16_f32 v32, 0, v32
    v_cvt_pk_bf16_f32 v33, 0, v33
    v_cvt_pk_bf16_f32 v34, 0, v34
    v_cvt_pk_bf16_f32 v35, 0, v35
    v_cvt_pk_bf16_f32 v36, 0, v36
    v_cvt_pk_bf16_f32 v37, 0, v37
    v_pk_mul_f32 v[28:29], v[28:29], v[48:49] op_sel_hi:[1,0]
    v_pk_mul_f32 v[30:31], v[30:31], v[48:49] op_sel_hi:[1,0]
    v_pk_mul_f32 v[32:33], v[32:33], v[48:49] op_sel_hi:[1,0]
    v_pk_mul_f32 v[34:35], v[34:35], v[48:49] op_sel_hi:[1,0]
    v_pk_mul_f32 v[36:37], v[36:37], v[48:49] op_sel_hi:[1,0]
    v_cvt_pk_bf16_f32 v40, v28, v29
    v_cvt_pk_bf16_f32 v41, v30, v31
    v_cvt_pk_bf16_f32 v42, v32, v33
    v_cvt_pk_bf16_f32 v43, v34, v35
    v_cvt_pk_bf16_f32 v44, v36, v37
    ds_write2_b32 v26, v40, v41 offset0:0 offset1:32
    ds_write2_b32 v26, v42, v43 offset0:64 offset1:96
    ds_write_b32 v26, v44 offset:512
    s_cbranch_execz L_dry_out
L_noln_37:
    s_waitcnt lgkmcnt(0)
    s_barrier
L_dry_1:
    ds_read_b128 v[28:31], v23
    ds_read_b128 v[32:35], v23 offset:64
    ds_read_b128 v[36:39], v24
    s_waitcnt lgkmcnt(2)
    v_smfmac_f32_16x16x64_bf16 v[50:53], v[28:31], v[80:87], v204
    v_smfmac_f32_16x16x64_bf16 v[54:57], v[28:31], v[100:107], v204
    ds_write_b64 v27, v[244:245] offset:4096
    v_smfmac_f32_16x16x64_bf16 v[58:61], v[28:31], v[120:127], v204
    ds_write_b64 v27, v[246:247] offset:4608
    v_smfmac_f32_16x16x64_bf16 v[240:243], v[28:31], v[140:147], v204
    ds_write_b64 v27, v[248:249] offset:5120
    s_waitcnt lgkmcnt(4)
    v_smfmac_f32_16x16x64_bf16 v[50:53], v[32:35], v[88:95], v204
    ds_write_b64 v27, v[250:251] offset:5632
    v_smfmac_f32_16x16x64_bf16 v[54:57], v[32:35], v[108:115], v204
    ds_write_b64 v27, v[252:253] offset:6144
    v_smfmac_f32_16x16x64_bf16 v[58:61], v[32:35], v[128:135], v204
    v_smfmac_f32_16x16x64_bf16 v[240:243], v[32:35], v[148:155], v204
    s_waitcnt lgkmcnt(5)
    v_smfmac_f32_16x16x64_bf16 v[50:53], v[36:39], v[92:99], v204
    v_smfmac_f32_16x16x64_bf16 v[54:57], v[36:39], v[112:119], v204
    v_smfmac_f32_16x16x64_bf16 v[58:61], v[36:39], v[132:139], v204
    v_smfmac_f32_16x16x64_bf16 v[240:243], v[36:39], v[152:159], v204
    s_lshr_b32 s35, s3, 1
    s_and_b32 s35, s35, s3
    s_mul_i32 s35, s35, s58
    s_cmp_lg_u32 s35, 0
    s_nop 0
    v_add_f32_dpp v48, v50, v52 quad_perm:[0,1,2,3] row_mask:0x1 bank_mask:0xf
    v_add_f32_dpp v49, v51, v53 quad_perm:[0,1,2,3] row_mask:0x1 bank_mask:0xf
    s_nop 0
    v_add_f32_dpp v48, v54, v56 quad_perm:[0,1,2,3] row_mask:0x2 bank_mask:0xf
    v_add_f32_dpp v49, v55, v57 quad_perm:[0,1,2,3] row_mask:0x2 bank_mask:0xf
    s_nop 0
    v_add_f32_dpp v48, v58, v60 quad_perm:[0,1,2,3] row_mask:0x4 bank_mask:0xf
    v_add_f32_dpp v49, v59, v61 quad_perm:[0,1,2,3] row_mask:0x4 bank_mask:0xf
    s_nop 0
    v_add_f32_dpp v48, v240, v242 quad_perm:[0,1,2,3] row_mask:0x8 bank_mask:0xf
    v_add_f32_dpp v49, v241, v243 quad_perm:[0,1,2,3] row_mask:0x8 bank_mask:0xf
    ds_write2_b32 v22, v48, v49 offset0:0 offset1:2
    s_waitcnt vmcnt(2)
    v_perm_b32 v160, v212, v208, s52
    v_perm_b32 v164, v212, v208, s53
    v_perm_b32 v168, v213, v209, s52
    v_perm_b32 v172, v213, v209, s53
    v_perm_b32 v176, v214, v210, s52
    v_perm_b32 v180, v214, v210, s53
    v_perm_b32 v184, v215, v211, s52
    v_perm_b32 v188, v215, v211, s53
    v_perm_b32 v161, v220, v216, s52
    v_perm_b32 v165, v220, v216, s53
    v_perm_b32 v169, v221, v217, s52
    v_perm_b32 v173, v221, v217, s53
    v_perm_b32 v177, v222, v218, s52
    v_perm_b32 v181, v222, v218, s53
    v_perm_b32 v185, v223, v219, s52
    v_perm_b32 v189, v223, v219, s53
    s_waitcnt lgkmcnt(0)
    s_barrier
L_dry_2:
    s_cbranch_scc1 L_idle_42
    ds_read_b64 v[28:29], v21 offset:12288
    ds_read_b64 v[30:31], v21 offset:12800
    ds_read_b64 v[32:33], v21 offset:13312
    ds_read_b64 v[34:35], v21 offset:13824
    ds_read2_b32 v[202:203], v197 offset0:0 offset1:4
    s_waitcnt vmcnt(0)
    v_perm_b32 v162, v228, v224, s52
    v_perm_b32 v166, v228, v224, s53
    v_perm_b32 v170, v229, v225, s52
    v_perm_b32 v174, v229, v225, s53
    v_perm_b32 v178, v230, v226, s52
    v_perm_b32 v182, v230, v226, s53
    v_perm_b32 v186, v231, v227, s52
    v_perm_b32 v190, v231, v227, s53
    v_perm_b32 v163, v236, v232, s52
    v_perm_b32 v167, v236, v232, s53
    v_perm_b32 v171, v237, v233, s52
    v_perm_b32 v175, v237, v233, s53
    v_perm_b32 v179, v238, v234, s52
    v_perm_b32 v183, v238, v234, s53
    v_perm_b32 v187, v239, v235, s52
    v_perm_b32 v191, v239, v235, s53
    s_waitcnt lgkmcnt(3)
    v_pk_add_f32 v[28:29], v[28:29], v[30:31]
    s_waitcnt lgkmcnt(1)
    v_pk_add_f32 v[32:33], v[32:33], v[34:35]
    v_pk_add_f32 v[28:29], v[28:29], v[32:33]
    v_cvt_pk_bf16_f32 v28, 0, v28
    v_cvt_pk_bf16_f32 v29, 0, v29
    v_pk_add_f32 v[28:29], v[28:29], v[194:195]
    v_cvt_pk_bf16_f32 v28, 0, v28
    v_cvt_pk_bf16_f32 v29, 0, v29
    v_pk_mul_f32 v[30:31], v[28:29], v[28:29]
    v_pk_fma_f32 v[30:31], v[30:31], v[200:201], v[200:201] op_sel:[0,0,1] op_sel_hi:[1,0,1]
    v_pk_mul_f32 v[30:31], v[30:31], v[28:29]
    v_exp_f32 v30, v30
    v_exp_f32 v31, v31
    v_add_f32 v30, 1.0, v30
    v_add_f32 v31, 1.0, v31
    v_rcp_f32 v30, v30
    v_rcp_f32 v31, v31
    v_mul_f32 v28, v28, v30
    v_mul_f32 v29, v29, v31
    v_cvt_pk_bf16_f32 v28, v28, v29
    s_nop 1
    v_mov_b32_dpp v64, v28 quad_perm:[0,1,2,3] row_mask:0xf bank_mask:0x1
    v_mov_b32_dpp v65, v28 row_ror:12 row_mask:0xf bank_mask:0x1
    v_mov_b32_dpp v66, v28 row_ror:8 row_mask:0xf bank_mask:0x1
    v_mov_b32_dpp v67, v28 row_ror:4 row_mask:0xf bank_mask:0x1
    v_mov_b32_dpp v68, v28 row_ror:4 row_mask:0xf bank_mask:0x2
    v_mov_b32_dpp v69, v28 quad_perm:[0,1,2,3] row_mask:0xf bank_mask:0x2
    v_mov_b32_dpp v70, v28 row_ror:12 row_mask:0xf bank_mask:0x2
    v_mov_b32_dpp v71, v28 row_ror:8 row_mask:0xf bank_mask:0x2
    v_mfma_f32_16x16x32_bf16 v[44:47], v[64:67], v[160:163], 0
    v_mfma_f32_16x16x32_bf16 v[48:51], v[64:67], v[176:179], 0
    v_mov_b32_dpp v72, v28 row_ror:8 row_mask:0xf bank_mask:0x4
    v_mov_b32_dpp v73, v28 row_ror:4 row_mask:0xf bank_mask:0x4
    v_mov_b32_dpp v74, v28 quad_perm:[0,1,2,3] row_mask:0xf bank_mask:0x4
    v_mov_b32_dpp v75, v28 row_ror:12 row_mask:0xf bank_mask:0x4
    v_mfma_f32_16x16x32_bf16 v[44:47], v[68:71], v[164:167], v[44:47]
    v_mfma_f32_16x16x32_bf16 v[48:51], v[68:71], v[180:183], v[48:51]
    v_mov_b32_dpp v76, v28 row_ror:12 row_mask:0xf bank_mask:0x8
    v_mov_b32_dpp v77, v28 row_ror:8 row_mask:0xf bank_mask:0x8
    v_mov_b32_dpp v78, v28 row_ror:4 row_mask:0xf bank_mask:0x8
    v_mov_b32_dpp v79, v28 quad_perm:[0,1,2,3] row_mask:0xf bank_mask:0x8
    v_mfma_f32_16x16x32_bf16 v[44:47], v[72:75], v[168:171], v[44:47]
    v_mfma_f32_16x16x32_bf16 v[48:51], v[72:75], v[184:187], v[48:51]
    v_mfma_f32_16x16x32_bf16 v[44:47], v[76:79], v[172:175], v[44:47]
    v_mfma_f32_16x16x32_bf16 v[48:51], v[76:79], v[188:191], v[48:51]
    s_nop 6
    v_add_f32_dpp v32, v46, v44 row_ror:8 row_mask:0xf bank_mask:0x3
    v_add_f32_dpp v33, v50, v48 row_ror:8 row_mask:0xf bank_mask:0x3
    s_nop 0
    v_add_f32_dpp v32, v45, v47 row_ror:8 row_mask:0xf bank_mask:0xc
    v_add_f32_dpp v33, v49, v51 row_ror:8 row_mask:0xf bank_mask:0xc
    v_cvt_f64_f32 v[36:37], v32
    v_add_f64 v[36:37], v[36:37], s[60:61]
    global_atomic_add_x2 v[40:41], v25, v[36:37], s[28:29] offset:0 sc0 sc1
    v_cvt_f64_f32 v[38:39], v33
    v_add_f64 v[38:39], v[38:39], s[60:61]
    global_atomic_add_x2 v[42:43], v25, v[38:39], s[28:29] offset:1024 sc0 sc1
L_dry_3:
    s_waitcnt vmcnt(1) lgkmcnt(0)
    v_lshl_add_u64 v[40:41], v[40:41], 0, v[36:37]
    v_add_f64 v[40:41], v[40:41], -s[60:61]
    v_cvt_f32_f64 v44, v[40:41]
    s_waitcnt vmcnt(0)
    v_lshl_add_u64 v[42:43], v[42:43], 0, v[38:39]
    v_cmp_gt_f32 s[66:67], s62, |v44|
    v_add_f64 v[42:43], v[42:43], -s[60:61]
    v_cvt_pk_bf16_f32 v44, 0, v44
    v_cvt_f32_f64 v45, v[42:43]
    v_cmp_gt_f32 s[68:69], s62, |v45|
    v_cvt_pk_bf16_f32 v45, 0, v45
    v_pk_add_f32 v[44:45], v[44:45], v[192:193]
    v_cvt_pk_bf16_f32 v44, 0, v44
    v_cvt_pk_bf16_f32 v45, 0, v45
    v_pk_add_f32 v[44:45], v[44:45], v[202:203]
    v_cvt_pk_bf16_f32 v44, v44, v45
    s_mov_b64 exec, s[66:67]
    s_cbranch_execz L_nost_43
    global_store_short v199, v44, s[24:25]
L_nost_43:
    s_mov_b64 exec, s[68:69]
    s_cbranch_execz L_nost_44
    global_store_short_d16_hi v199, v44, s[24:25] offset:8
L_nost_44:
    s_endpgm
L_idle_42:
    s_cmp_lg_u32 s34, 6
    s_cbranch_scc1 L_idle_42_e
    v_mov_b32 v2, 524288
    v_mov_b32 v3, s43
    global_store_dword v2, v3, s[28:29] sc1
L_idle_42_e:
    s_endpgm
L_noln2_41:
    s_waitcnt vmcnt(0)
    ds_read_b64_tr_b16 v[80:81], v16 offset:0
    ds_read_b64_tr_b16 v[82:83], v16 offset:512
    ds_read_b64_tr_b16 v[100:101], v17 offset:0
    ds_read_b64_tr_b16 v[102:103], v17 offset:512
    ds_read_b64_tr_b16 v[120:121], v18 offset:0
    ds_read_b64_tr_b16 v[122:123], v18 offset:512
    ds_read_b64_tr_b16 v[140:141], v19 offset:0
    ds_read_b64_tr_b16 v[142:143], v19 offset:512
    ds_read_b64_tr_b16 v[84:85], v16 offset:4096
    ds_read_b64_tr_b16 v[86:87], v16 offset:4608
    ds_read_b64_tr_b16 v[104:105], v17 offset:4096
    ds_read_b64_tr_b16 v[106:107], v17 offset:4608
    ds_read_b64_tr_b16 v[124:125], v18 offset:4096
    ds_read_b64_tr_b16 v[126:127], v18 offset:4608
    ds_read_b64_tr_b16 v[144:145], v19 offset:4096
    ds_read_b64_tr_b16 v[146:147], v19 offset:4608
    ds_read_b64_tr_b16 v[88:89], v16 offset:8192
    ds_read_b64_tr_b16 v[90:91], v16 offset:8704
    ds_read_b64_tr_b16 v[108:109], v17 offset:8192
    ds_read_b64_tr_b16 v[110:111], v17 offset:8704
    ds_read_b64_tr_b16 v[128:129], v18 offset:8192
    ds_read_b64_tr_b16 v[130:131], v18 offset:8704
    ds_read_b64_tr_b16 v[148:149], v19 offset:8192
    ds_read_b64_tr_b16 v[150:151], v19 offset:8704
    ds_read_b64_tr_b16 v[92:93], v16 offset:12288
    ds_read_b64_tr_b16 v[94:95], v16 offset:12800
    ds_read_b64_tr_b16 v[112:113], v17 offset:12288
    ds_read_b64_tr_b16 v[114:115], v17 offset:12800
    ds_read_b64_tr_b16 v[132:133], v18 offset:12288
    ds_read_b64_tr_b16 v[134:135], v18 offset:12800
    ds_read_b64_tr_b16 v[152:153], v19 offset:12288
    ds_read_b64_tr_b16 v[154:155], v19 offset:12800
    ds_read_b64_tr_b16 v[96:97], v16 offset:16384
    ds_read_b64_tr_b16 v[98:99], v16 offset:16896
    ds_read_b64_tr_b16 v[116:117], v17 offset:16384
    ds_read_b64_tr_b16 v[118:119], v17 offset:16896
    ds_read_b64_tr_b16 v[136:137], v18 offset:16384
    ds_read_b64_tr_b16 v[138:139], v18 offset:16896
    ds_read_b64_tr_b16 v[156:157], v19 offset:16384
    ds_read_b64_tr_b16 v[158:159], v19 offset:16896
    s_and_b32 s35, s3, 1
    s_mul_i32 s35, s35, s58
    s_cmp_lg_u32 s35, 0
    s_cbranch_scc1 L_noln_37
    global_load_dwordx4 v[208:211], v15, s[44:45]
    v_add_u32 v15, s46, v15
    global_load_dwordx4 v[212:215], v15, s[44:45]
    v_add_u32 v15, s46, v15
    global_load_dwordx4 v[216:219], v15, s[44:45]
    v_add_u32 v15, s46, v15
    global_load_dwordx4 v[220:223], v15, s[44:45]
    v_add_u32 v15, s46, v15
    global_load_dwordx4 v[224:227], v15, s[44:45]
    v_add_u32 v15, s46, v15
    global_load_dwordx4 v[228:231], v15, s[44:45]
    v_add_u32 v15, s46, v15
    global_load_dwordx4 v[232:235], v15, s[44:45]
    v_add_u32 v15, s46, v15
    global_load_dwordx4 v[236:239], v15, s[44:45]
    s_branch L_noln_37
L_compute:
    v_readfirstlane_b32 s43, v2
    ds_read_b128 v[144:147], v200
    ds_read_b128 v[148:151], v201
    ds_read_b128 v[152:155], v202
    ds_read_b128 v[156:159], v203
    s_waitcnt lgkmcnt(3)
    v_mfma_f32_16x16x32_bf16 v[160:163], v[16:19], v[144:147], 0
    v_mfma_f32_16x16x32_bf16 v[164:167], v[32:35], v[144:147], 0
    v_mfma_f32_16x16x32_bf16 v[168:171], v[48:51], v[144:147], 0
    v_mfma_f32_16x16x32_bf16 v[172:175], v[64:67], v[144:147], 0
    s_waitcnt lgkmcnt(2)
    v_mfma_f32_16x16x32_bf16 v[160:163], v[20:23], v[148:151], v[160:163]
    v_mfma_f32_16x16x32_bf16 v[164:167], v[36:39], v[148:151], v[164:167]
    v_mfma_f32_16x16x32_bf16 v[168:171], v[52:55], v[148:151], v[168:171]
    v_mfma_f32_16x16x32_bf16 v[172:175], v[68:71], v[148:151], v[172:175]
    s_waitcnt lgkmcnt(1)
    v_mfma_f32_16x16x32_bf16 v[160:163], v[24:27], v[152:155], v[160:163]
    v_mfma_f32_16x16x32_bf16 v[164:167], v[40:43], v[152:155], v[164:167]
    v_mfma_f32_16x16x32_bf16 v[168:171], v[56:59], v[152:155], v[168:171]
    v_mfma_f32_16x16x32_bf16 v[172:175], v[72:75], v[152:155], v[172:175]
    s_waitcnt lgkmcnt(0)
    v_mfma_f32_16x16x32_bf16 v[160:163], v[28:31], v[156:159], v[160:163]
    v_mfma_f32_16x16x32_bf16 v[164:167], v[44:47], v[156:159], v[164:167]
    v_mfma_f32_16x16x32_bf16 v[168:171], v[60:63], v[156:159], v[168:171]
    v_mfma_f32_16x16x32_bf16 v[172:175], v[76:79], v[156:159], v[172:175]
    s_nop 4
    v_mov_b32_dpp v16, v160 quad_perm:[0,0,0,0] row_mask:0xf bank_mask:0xf
    v_mov_b32_dpp v17, v164 quad_perm:[0,0,0,0] row_mask:0xf bank_mask:0xf
    v_mov_b32_dpp v18, v168 quad_perm:[0,0,0,0] row_mask:0xf bank_mask:0xf
    v_mov_b32_dpp v19, v172 quad_perm:[0,0,0,0] row_mask:0xf bank_mask:0xf
    v_add_f32_dpp v16, v161, v16 quad_perm:[1,1,1,1] row_mask:0xf bank_mask:0xf
    v_add_f32_dpp v17, v165, v17 quad_perm:[1,1,1,1] row_mask:0xf bank_mask:0xf
    v_add_f32_dpp v18, v169, v18 quad_perm:[1,1,1,1] row_mask:0xf bank_mask:0xf
    v_add_f32_dpp v19, v173, v19 quad_perm:[1,1,1,1] row_mask:0xf bank_mask:0xf
    v_add_f32_dpp v16, v162, v16 quad_perm:[2,2,2,2] row_mask:0xf bank_mask:0xf
    v_add_f32_dpp v17, v166, v17 quad_perm:[2,2,2,2] row_mask:0xf bank_mask:0xf
    v_add_f32_dpp v18, v170, v18 quad_perm:[2,2,2,2] row_mask:0xf bank_mask:0xf
    v_add_f32_dpp v19, v174, v19 quad_perm:[2,2,2,2] row_mask:0xf bank_mask:0xf
    v_add_f32_dpp v16, v163, v16 quad_perm:[3,3,3,3] row_mask:0xf bank_mask:0xf
    v_add_f32_dpp v17, v167, v17 quad_perm:[3,3,3,3] row_mask:0xf bank_mask:0xf
    v_add_f32_dpp v18, v171, v18 quad_perm:[3,3,3,3] row_mask:0xf bank_mask:0xf
    v_add_f32_dpp v19, v175, v19 quad_perm:[3,3,3,3] row_mask:0xf bank_mask:0xf
    v_cvt_pk_bf16_f32 v16, 0, v16
    v_cvt_pk_bf16_f32 v17, 0, v17
    v_cvt_pk_bf16_f32 v18, 0, v18
    v_cvt_pk_bf16_f32 v19, 0, v19
    v_pk_mul_f32 v[16:17], v[16:17], s[40:41] op_sel_hi:[1,0]
    v_pk_mul_f32 v[18:19], v[18:19], s[40:41] op_sel_hi:[1,0]
    v_cvt_pk_bf16_f32 v16, 0, v16
    v_cvt_pk_bf16_f32 v17, 0, v17
    v_cvt_pk_bf16_f32 v18, 0, v18
    v_cvt_pk_bf16_f32 v19, 0, v19
    v_max3_f32 v28, v16, v17, v18
    v_max_f32 v28, v28, v19
    s_nop 1
    v_max_f32_dpp v28, v28, v28 row_ror:4 row_mask:0xf bank_mask:0xf
    s_nop 1
    v_max_f32_dpp v28, v28, v28 row_ror:8 row_mask:0xf bank_mask:0xf
    v_mov_b32 v29, v28
    s_nop 1
    v_permlane32_swap_b32 v28, v29
    v_max_f32 v28, v28, v29
    v_mov_b32 v29, v28
    s_nop 1
    v_permlane16_swap_b32 v28, v29
    v_max_f32 v28, v28, v29
    v_pk_add_f32 v[16:17], v[16:17], v[28:29] op_sel_hi:[1,0] neg_lo:[0,1] neg_hi:[0,1]
    v_pk_add_f32 v[18:19], v[18:19], v[28:29] op_sel_hi:[1,0] neg_lo:[0,1] neg_hi:[0,1]
    v_pk_mul_f32 v[16:17], v[16:17], s[48:49] op_sel_hi:[1,0]
    v_pk_mul_f32 v[18:19], v[18:19], s[48:49] op_sel_hi:[1,0]
    v_exp_f32 v16, v16
    v_exp_f32 v17, v17
    v_exp_f32 v18, v18
    v_exp_f32 v19, v19
    s_nop 0
    v_pk_add_f32 v[30:31], v[16:17], v[18:19]
    v_add_f32 v30, v30, v31
    v_cvt_pk_bf16_f32 v24, 0, v16
    v_cvt_pk_bf16_f32 v25, 0, v17
    v_add_f32_dpp v30, v30, v30 row_ror:4 row_mask:0xf bank_mask:0xf
    v_cvt_pk_bf16_f32 v26, 0, v18
    v_cvt_pk_bf16_f32 v27, 0, v19
    v_add_f32_dpp v30, v30, v30 row_ror:8 row_mask:0xf bank_mask:0xf
    v_mov_b32 v31, v30
    v_pk_add_f32 v[16:17], v[16:17], v[24:25] neg_lo:[0,1] neg_hi:[0,1]
    v_pk_add_f32 v[18:19], v[18:19], v[26:27] neg_lo:[0,1] neg_hi:[0,1]
    v_permlane32_swap_b32 v30, v31
    v_add_f32 v30, v30, v31
    v_mov_b32 v31, v30
    v_cvt_pk_bf16_f32 v20, v24, v16
    v_cvt_pk_bf16_f32 v21, v25, v17
    v_permlane16_swap_b32 v30, v31
    v_add_f32 v29, v30, v31
    v_cvt_pk_bf16_f32 v22, v26, v18
    v_cvt_pk_bf16_f32 v23, v27, v19
    ds_write_b64 v12, v[28:29] offset:3072
    s_nop 1
    s_setpc_b64 s[50:51]
L_ctrl:
    v_and_b32 v2, 1, v0
    v_cmp_eq_u32 vcc, 1, v2
    v_mov_b32 v2, 0x0c0c0100
    v_mov_b32 v3, 0x01000c0c
    v_cndmask_b32 v12, v2, v3, vcc
    v_mov_b32 v2, 0x0c0c0302
    v_mov_b32 v3, 0x03020c0c
    v_cndmask_b32 v13, v2, v3, vcc
    v_bfe_u32 v2, v0, 1, 2
    v_mov_b32 v3, 0x0c0c0c0c
    v_cmp_eq_u32 vcc, 0, v2
    s_nop 1
    v_cndmask_b32 v4, v3, v12, vcc
    v_cndmask_b32 v8, v3, v13, vcc
    v_cmp_eq_u32 vcc, 1, v2
    s_nop 1
    v_cndmask_b32 v5, v3, v12, vcc
    v_cndmask_b32 v9, v3, v13, vcc
    v_cmp_eq_u32 vcc, 2, v2
    s_nop 1
    v_cndmask_b32 v6, v3, v12, vcc
    v_cndmask_b32 v10, v3, v13, vcc
    v_cmp_eq_u32 vcc, 3, v2
    s_nop 1
    v_cndmask_b32 v7, v3, v12, vcc
    v_cndmask_b32 v11, v3, v13, vcc
    s_getreg_b32 s44, hwreg(HW_REG_XCC_ID, 0, 3)
    v_lshl_add_u32 v21, v0, 4, s45
    s_waitcnt vmcnt(22)
    v_lshlrev_b32 v36, 16, v24
    v_and_b32 v37, 0xffff0000, v24
    v_lshlrev_b32 v38, 16, v25
    v_and_b32 v39, 0xffff0000, v25
    v_lshlrev_b32 v40, 16, v26
    v_and_b32 v41, 0xffff0000, v26
    v_lshlrev_b32 v42, 16, v27
    v_and_b32 v43, 0xffff0000, v27
    v_lshlrev_b32 v44, 16, v28
    v_and_b32 v45, 0xffff0000, v28
    v_pk_add_f32 v[60:61], v[36:37], v[38:39]
    v_pk_mul_f32 v[62:63], v[36:37], v[36:37]
    v_pk_add_f32 v[60:61], v[60:61], v[40:41]
    v_pk_fma_f32 v[62:63], v[38:39], v[38:39], v[62:63]
    v_pk_add_f32 v[60:61], v[60:61], v[42:43]
    v_pk_fma_f32 v[62:63], v[40:41], v[40:41], v[62:63]
    v_pk_add_f32 v[60:61], v[60:61], v[44:45]
    v_pk_fma_f32 v[62:63], v[42:43], v[42:43], v[62:63]
    v_pk_fma_f32 v[62:63], v[44:45], v[44:45], v[62:63]
    v_add_f32 v62, v62, v63
    v_add_f32 v60, v60, v61
    s_nop 1
    v_permlane32_swap_b32 v60, v62
    v_add_f32 v60, v60, v62
    s_nop 1
    v_add_f32_dpp v60, v60, v60 quad_perm:[1,0,3,2] row_mask:0xf bank_mask:0xf
    s_nop 1
    v_add_f32_dpp v60, v60, v60 quad_perm:[2,3,0,1] row_mask:0xf bank_mask:0xf
    s_nop 1
    v_add_f32_dpp v60, v60, v60 row_half_mirror row_mask:0xf bank_mask:0xf
    s_nop 1
    v_add_f32_dpp v60, v60, v60 row_mirror row_mask:0xf bank_mask:0xf
    s_nop 1
    v_add_f32_dpp v60, v60, v60 row_bcast:15 row_mask:0xa bank_mask:0xf
    v_mul_f32 v60, 0x3acccccd, v60
    s_nop 0
    v_readlane_b32 s41, v60, 63
    v_readlane_b32 s40, v60, 31
    s_nop 0
    v_mov_b32 v62, s41
    v_cvt_pk_bf16_f32 v60, 0, s40
    v_fma_f32 v62, -s40, s40, v62
    v_pk_add_f32 v[36:37], v[36:37], v[60:61] op_sel_hi:[1,0] neg_lo:[0,1] neg_hi:[0,1]
    v_max_f32 v62, 0, v62
    v_pk_add_f32 v[38:39], v[38:39], v[60:61] op_sel_hi:[1,0] neg_lo:[0,1] neg_hi:[0,1]
    v_cvt_pk_bf16_f32 v62, 0, v62
    v_pk_add_f32 v[40:41], v[40:41], v[60:61] op_sel_hi:[1,0] neg_lo:[0,1] neg_hi:[0,1]
    v_add_f32 v62, 0x3727c5ac, v62
    v_pk_add_f32 v[42:43], v[42:43], v[60:61] op_sel_hi:[1,0] neg_lo:[0,1] neg_hi:[0,1]
    v_cvt_pk_bf16_f32 v62, 0, v62
    v_pk_add_f32 v[44:45], v[44:45], v[60:61] op_sel_hi:[1,0] neg_lo:[0,1] neg_hi:[0,1]
    v_sqrt_f32 v62, v62
    v_cvt_pk_bf16_f32 v36, 0, v36
    v_cvt_pk_bf16_f32 v37, 0, v37
    v_cvt_pk_bf16_f32 v62, 0, v62
    v_cvt_pk_bf16_f32 v38, 0, v38
    v_rcp_f32 v62, v62
    v_cvt_pk_bf16_f32 v39, 0, v39
    v_cvt_pk_bf16_f32 v40, 0, v40
    v_cvt_pk_bf16_f32 v41, 0, v41
    v_cvt_pk_bf16_f32 v42, 0, v42
    v_cvt_pk_bf16_f32 v43, 0, v43
    v_cvt_pk_bf16_f32 v44, 0, v44
    v_cvt_pk_bf16_f32 v45, 0, v45
    v_pk_mul_f32 v[36:37], v[36:37], v[62:63] op_sel_hi:[1,0]
    v_pk_mul_f32 v[38:39], v[38:39], v[62:63] op_sel_hi:[1,0]
    v_pk_mul_f32 v[40:41], v[40:41], v[62:63] op_sel_hi:[1,0]
    v_pk_mul_f32 v[42:43], v[42:43], v[62:63] op_sel_hi:[1,0]
    v_pk_mul_f32 v[44:45], v[44:45], v[62:63] op_sel_hi:[1,0]
    v_cvt_pk_bf16_f32 v24, v36, v37
    v_cvt_pk_bf16_f32 v25, v38, v39
    v_cvt_pk_bf16_f32 v26, v40, v41
    v_cvt_pk_bf16_f32 v27, v42, v43
    v_cvt_pk_bf16_f32 v28, v44, v45
    v_lshlrev_b32 v2, 2, v0
    ds_write_b64 v1, v[24:25] offset:0
    ds_write_b64 v1, v[26:27] offset:512
    ds_write_b32 v2, v28 offset:1024
    v_lshlrev_b32 v48, 16, v30
    v_and_b32 v49, 0xffff0000, v30
    v_lshlrev_b32 v50, 16, v31
    v_and_b32 v51, 0xffff0000, v31
    v_lshlrev_b32 v52, 16, v32
    v_and_b32 v53, 0xffff0000, v32
    v_lshlrev_b32 v54, 16, v33
    v_and_b32 v55, 0xffff0000, v33
    v_lshlrev_b32 v56, 16, v34
    v_and_b32 v57, 0xffff0000, v34
    v_pk_add_f32 v[60:61], v[48:49], v[50:51]
    v_pk_mul_f32 v[62:63], v[48:49], v[48:49]
    v_pk_add_f32 v[60:61], v[60:61], v[52:53]
    v_pk_fma_f32 v[62:63], v[50:51], v[50:51], v[62:63]
    v_pk_add_f32 v[60:61], v[60:61], v[54:55]
    v_pk_fma_f32 v[62:63], v[52:53], v[52:53], v[62:63]
    v_pk_add_f32 v[60:61], v[60:61], v[56:57]
    v_pk_fma_f32 v[62:63], v[54:55], v[54:55], v[62:63]
    v_pk_fma_f32 v[62:63], v[56:57], v[56:57], v[62:63]
    v_add_f32 v62, v62, v63
    v_add_f32 v60, v60, v61
    s_nop 1
    v_permlane32_swap_b32 v60, v62
    v_add_f32 v60, v60, v62
    s_nop 1
    v_add_f32_dpp v60, v60, v60 quad_perm:[1,0,3,2] row_mask:0xf bank_mask:0xf
    s_nop 1
    v_add_f32_dpp v60, v60, v60 quad_perm:[2,3,0,1] row_mask:0xf bank_mask:0xf
    s_nop 1
    v_add_f32_dpp v60, v60, v60 row_half_mirror row_mask:0xf bank_mask:0xf
    s_nop 1
    v_add_f32_dpp v60, v60, v60 row_mirror row_mask:0xf bank_mask:0xf
    s_nop 1
    v_add_f32_dpp v60, v60, v60 row_bcast:15 row_mask:0xa bank_mask:0xf
    v_mul_f32 v60, 0x3acccccd, v60
    s_nop 0
    v_readlane_b32 s41, v60, 63
    v_readlane_b32 s40, v60, 31
    s_nop 0
    v_mov_b32 v62, s41
    v_cvt_pk_bf16_f32 v60, 0, s40
    v_fma_f32 v62, -s40, s40, v62
    v_pk_add_f32 v[48:49], v[48:49], v[60:61] op_sel_hi:[1,0] neg_lo:[0,1] neg_hi:[0,1]
    v_max_f32 v62, 0, v62
    v_pk_add_f32 v[50:51], v[50:51], v[60:61] op_sel_hi:[1,0] neg_lo:[0,1] neg_hi:[0,1]
    v_cvt_pk_bf16_f32 v62, 0, v62
    v_pk_add_f32 v[52:53], v[52:53], v[60:61] op_sel_hi:[1,0] neg_lo:[0,1] neg_hi:[0,1]
    v_add_f32 v62, 0x3727c5ac, v62
    v_pk_add_f32 v[54:55], v[54:55], v[60:61] op_sel_hi:[1,0] neg_lo:[0,1] neg_hi:[0,1]
    v_cvt_pk_bf16_f32 v62, 0, v62
    v_pk_add_f32 v[56:57], v[56:57], v[60:61] op_sel_hi:[1,0] neg_lo:[0,1] neg_hi:[0,1]
    v_sqrt_f32 v62, v62
    v_cvt_pk_bf16_f32 v48, 0, v48
    v_cvt_pk_bf16_f32 v49, 0, v49
    v_cvt_pk_bf16_f32 v62, 0, v62
    v_cvt_pk_bf16_f32 v50, 0, v50
    v_rcp_f32 v62, v62
    v_cvt_pk_bf16_f32 v51, 0, v51
    v_cvt_pk_bf16_f32 v52, 0, v52
    v_cvt_pk_bf16_f32 v53, 0, v53
    v_cvt_pk_bf16_f32 v54, 0, v54
    v_cvt_pk_bf16_f32 v55, 0, v55
    v_cvt_pk_bf16_f32 v56, 0, v56
    v_cvt_pk_bf16_f32 v57, 0, v57
    v_pk_mul_f32 v[48:49], v[48:49], v[62:63] op_sel_hi:[1,0]
    v_pk_mul_f32 v[50:51], v[50:51], v[62:63] op_sel_hi:[1,0]
    v_pk_mul_f32 v[52:53], v[52:53], v[62:63] op_sel_hi:[1,0]
    v_pk_mul_f32 v[54:55], v[54:55], v[62:63] op_sel_hi:[1,0]
    v_pk_mul_f32 v[56:57], v[56:57], v[62:63] op_sel_hi:[1,0]
    v_cvt_pk_bf16_f32 v30, v48, v49
    v_cvt_pk_bf16_f32 v31, v50, v51
    v_cvt_pk_bf16_f32 v32, v52, v53
    v_cvt_pk_bf16_f32 v33, v54, v55
    v_cvt_pk_bf16_f32 v34, v56, v57
    v_lshlrev_b32 v2, 2, v0
    ds_write_b64 v1, v[30:31] offset:1408
    ds_write_b64 v1, v[32:33] offset:1920
    ds_write_b32 v2, v34 offset:2432
    s_mul_i32 s35, s33, 160
    v_lshrrev_b32 v2, 4, v0
    v_mul_u32_u24 v2, 40, v2
    v_bfe_u32 v3, v0, 3, 1
    v_mul_u32_u24 v3, 1408, v3
    v_add3_u32 v2, v2, v3, s35
    s_waitcnt lgkmcnt(0)
    ds_read_b64 v[36:37], v2 offset:0
    ds_read_b64 v[38:39], v2 offset:8
    ds_read_b64 v[40:41], v2 offset:16
    ds_read_b64 v[42:43], v2 offset:24
    ds_read_b64 v[44:45], v2 offset:32
    s_waitcnt vmcnt(18)
    v_readfirstlane_b32 s43, v15
    s_nop 0
    s_add_u32 s43, s43, 1
    s_and_b32 s43, s43, 0x1fffffff
    s_mov_b32 s49, 0xffffff00
    v_mov_b32 v13, 0
    v_mov_b32 v245, s43
    v_and_b32 v2, 1, v0
    v_lshl_add_u32 v2, v2, 4, 8
    v_lshrrev_b32 v246, v2, v245
    v_add_u32 v246, s43, v246
    v_and_b32 v246, 0xff, v246
    v_add_u32 v2, 8, v2
    v_min_u32 v2, 31, v2
    v_lshrrev_b32 v247, v2, v245
    v_add_u32 v247, s43, v247
    v_and_b32 v247, 0xff, v247
    v_and_b32 v2, 3, v0
    v_mul_u32_u24 v2, 12, v2
    v_add_u32 v3, 3, v2
    v_min_u32 v3, 31, v3
    v_lshrrev_b32 v3, v3, v245
    v_add_u32 v3, s43, v3
    s_lshl_b32 s35, s44, 3
    s_and_b32 s35, s35, 8
    v_and_or_b32 v56, v3, 7, s35
    v_add_u32 v3, 6, v2
    v_min_u32 v3, 31, v3
    v_lshrrev_b32 v3, v3, v245
    v_add_u32 v3, s43, v3
    s_lshl_b32 s35, s44, 2
    s_and_b32 s35, s35, 8
    v_and_or_b32 v57, v3, 7, s35
    v_add_u32 v3, 9, v2
    v_min_u32 v3, 31, v3
    v_lshrrev_b32 v3, v3, v245
    v_add_u32 v3, s43, v3
    s_lshl_b32 s35, s44, 1
    s_and_b32 s35, s35, 8
    v_and_or_b32 v58, v3, 7, s35
    v_add_u32 v3, 12, v2
    v_min_u32 v3, 31, v3
    v_lshrrev_b32 v3, v3, v245
    v_add_u32 v3, s43, v3
    s_lshl_b32 s35, s44, 0
    s_and_b32 s35, s35, 8
    v_and_or_b32 v59, v3, 7, s35
    s_lshl_b32 s44, s44, 29
    s_or_b32 s44, s44, s43
    s_mov_b32 s43, s44
    v_mov_b32 v245, s44
    s_waitcnt lgkmcnt(0)
    v_perm_b32 v160, v36, v36, v4
    v_perm_b32 v161, v36, v36, v5
    v_perm_b32 v162, v36, v36, v6
    v_perm_b32 v163, v36, v36, v7
    v_perm_b32 v164, v36, v36, v8
    v_perm_b32 v165, v36, v36, v9
    v_perm_b32 v166, v36, v36, v10
    v_perm_b32 v167, v36, v36, v11
    s_waitcnt vmcnt(21)
    v_mfma_f32_16x16x32_bf16 v[48:51], v[160:163], v[80:83], 0
    v_perm_b32 v168, v37, v37, v4
    v_perm_b32 v169, v37, v37, v5
    v_perm_b32 v170, v37, v37, v6
    v_perm_b32 v171, v37, v37, v7
    s_waitcnt vmcnt(20)
    v_mfma_f32_16x16x32_bf16 v[48:51], v[164:167], v[84:87], v[48:51]
    v_perm_b32 v172, v37, v37, v8
    v_perm_b32 v173, v37, v37, v9
    v_perm_b32 v174, v37, v37, v10
    v_perm_b32 v175, v37, v37, v11
    s_waitcnt vmcnt(19)
    v_mfma_f32_16x16x32_bf16 v[48:51], v[168:171], v[88:91], v[48:51]
    v_perm_b32 v160, v38, v38, v4
    v_perm_b32 v161, v38, v38, v5
    v_perm_b32 v162, v38, v38, v6
    v_perm_b32 v163, v38, v38, v7
    s_waitcnt vmcnt(16)
    v_mfma_f32_16x16x32_bf16 v[48:51], v[172:175], v[92:95], v[48:51]
    v_perm_b32 v164, v38, v38, v8
    v_perm_b32 v165, v38, v38, v9
    v_perm_b32 v166, v38, v38, v10
    v_perm_b32 v167, v38, v38, v11
    s_waitcnt vmcnt(15)
    v_mfma_f32_16x16x32_bf16 v[48:51], v[160:163], v[96:99], v[48:51]
    v_perm_b32 v168, v39, v39, v4
    v_perm_b32 v169, v39, v39, v5
    v_perm_b32 v170, v39, v39, v6
    v_perm_b32 v171, v39, v39, v7
    s_waitcnt vmcnt(14)
    v_mfma_f32_16x16x32_bf16 v[48:51], v[164:167], v[100:103], v[48:51]
    v_perm_b32 v172, v39, v39, v8
    v_perm_b32 v173, v39, v39, v9
    v_perm_b32 v174, v39, v39, v10
    v_perm_b32 v175, v39, v39, v11
    s_waitcnt vmcnt(13)
    v_mfma_f32_16x16x32_bf16 v[48:51], v[168:171], v[104:107], v[48:51]
    v_perm_b32 v160, v40, v40, v4
    v_perm_b32 v161, v40, v40, v5
    v_perm_b32 v162, v40, v40, v6
    v_perm_b32 v163, v40, v40, v7
    s_waitcnt vmcnt(12)
    v_mfma_f32_16x16x32_bf16 v[48:51], v[172:175], v[108:111], v[48:51]
    v_perm_b32 v164, v40, v40, v8
    v_perm_b32 v165, v40, v40, v9
    v_perm_b32 v166, v40, v40, v10
    v_perm_b32 v167, v40, v40, v11
    s_waitcnt vmcnt(11)
    v_mfma_f32_16x16x32_bf16 v[48:51], v[160:163], v[112:115], v[48:51]
    v_perm_b32 v168, v41, v41, v4
    v_perm_b32 v169, v41, v41, v5
    v_perm_b32 v170, v41, v41, v6
    v_perm_b32 v171, v41, v41, v7
    s_waitcnt vmcnt(10)
    v_mfma_f32_16x16x32_bf16 v[48:51], v[164:167], v[116:119], v[48:51]
    v_perm_b32 v172, v41, v41, v8
    v_perm_b32 v173, v41, v41, v9
    v_perm_b32 v174, v41, v41, v10
    v_perm_b32 v175, v41, v41, v11
    s_waitcnt vmcnt(9)
    v_mfma_f32_16x16x32_bf16 v[48:51], v[168:171], v[120:123], v[48:51]
    v_perm_b32 v160, v42, v42, v4
    v_perm_b32 v161, v42, v42, v5
    v_perm_b32 v162, v42, v42, v6
    v_perm_b32 v163, v42, v42, v7
    s_waitcnt vmcnt(8)
    v_mfma_f32_16x16x32_bf16 v[48:51], v[172:175], v[124:127], v[48:51]
    v_perm_b32 v164, v42, v42, v8
    v_perm_b32 v165, v42, v42, v9
    v_perm_b32 v166, v42, v42, v10
    v_perm_b32 v167, v42, v42, v11
    s_waitcnt vmcnt(7)
    v_mfma_f32_16x16x32_bf16 v[48:51], v[160:163], v[128:131], v[48:51]
    v_perm_b32 v168, v43, v43, v4
    v_perm_b32 v169, v43, v43, v5
    v_perm_b32 v170, v43, v43, v6
    v_perm_b32 v171, v43, v43, v7
    s_waitcnt vmcnt(6)
    v_mfma_f32_16x16x32_bf16 v[48:51], v[164:167], v[132:135], v[48:51]
    v_perm_b32 v172, v43, v43, v8
    v_perm_b32 v173, v43, v43, v9
    v_perm_b32 v174, v43, v43, v10
    v_perm_b32 v175, v43, v43, v11
    s_waitcnt vmcnt(5)
    v_mfma_f32_16x16x32_bf16 v[48:51], v[168:171], v[136:139], v[48:51]
    v_perm_b32 v160, v44, v44, v4
    v_perm_b32 v161, v44, v44, v5
    v_perm_b32 v162, v44, v44, v6
    v_perm_b32 v163, v44, v44, v7
    s_waitcnt vmcnt(4)
    v_mfma_f32_16x16x32_bf16 v[48:51], v[172:175], v[140:143], v[48:51]
    v_perm_b32 v164, v44, v44, v8
    v_perm_b32 v165, v44, v44, v9
    v_perm_b32 v166, v44, v44, v10
    v_perm_b32 v167, v44, v44, v11
    s_waitcnt vmcnt(3)
    v_mfma_f32_16x16x32_bf16 v[48:51], v[160:163], v[144:147], v[48:51]
    v_perm_b32 v168, v45, v45, v4
    v_perm_b32 v169, v45, v45, v5
    v_perm_b32 v170, v45, v45, v6
    v_perm_b32 v171, v45, v45, v7
    s_waitcnt vmcnt(2)
    v_mfma_f32_16x16x32_bf16 v[48:51], v[164:167], v[148:151], v[48:51]
    v_perm_b32 v172, v45, v45, v8
    v_perm_b32 v173, v45, v45, v9
    v_perm_b32 v174, v45, v45, v10
    v_perm_b32 v175, v45, v45, v11
    s_waitcnt vmcnt(1)
    v_mfma_f32_16x16x32_bf16 v[48:51], v[168:171], v[152:155], v[48:51]
    s_waitcnt vmcnt(0)
    v_mfma_f32_16x16x32_bf16 v[48:51], v[172:175], v[156:159], v[48:51]
    s_nop 7
    v_and_or_b32 v52, v48, -16, v56
    v_and_or_b32 v53, v49, -16, v57
    v_and_or_b32 v54, v50, -16, v58
    v_and_or_b32 v55, v51, -16, v59
    global_store_dwordx4 v21, v[52:55], s[28:29]
    s_lshl_b32 s45, s32, 13
    s_add_u32 s45, s45, 262144
    s_lshl_b32 s35, s33, 2
    v_and_b32 v2, 3, v0
    v_add_u32 v2, s35, v2
    v_cmp_lt_u32 vcc, 3, v0
    s_nop 1
    v_cndmask_b32 v2, v2, 32, vcc
    v_lshl_add_u32 v2, v2, 7, s45
    global_load_dword v253, v2, s[28:29]
    s_and_b32 s39, s32, 3
    s_lshl_b32 s39, s39, 3
    s_add_u32 s39, s39, s30
    s_cmp_lt_u32 s39, 27
    s_cselect_b32 s31, 1, 2
    s_min_u32 s39, s39, 26
    s_cmp_lt_u32 s33, 5
    s_cselect_b32 s31, 0, s31
    s_and_b32 s58, s34, 31
    s_cmp_eq_u32 s58, 31
    s_cbranch_scc1 L_zinit_51
L_zinit_51_r:
    v_lshrrev_b32 v3, 5, v0
    v_and_b32 v22, 31, v0
    v_and_b32 v2, 7, v0
    v_lshlrev_b32 v2, 2, v2
    v_add_u32 v23, 528384, v2
    s_lshl_b32 s35, s32, 15
    s_lshr_b32 s38, s33, 2
    s_lshl_b32 s38, s38, 9
    s_add_u32 s35, s35, s38
    s_add_u32 s35, s35, 1048576
    v_lshlrev_b32 v2, 12, v3
    v_lshl_add_u32 v2, v22, 4, v2
    v_add_u32 v60, s35, v2
    v_add_u32 v61, 8192, v60
    v_add_u32 v62, 8192, v61
    v_add_u32 v63, 8192, v62
    v_and_b32 v2, 15, v0
    v_lshlrev_b32 v2, 4, v2
    v_and_b32 v22, 16, v0
    v_lshrrev_b32 v22, 1, v22
    v_add_u32 v2, v2, v22
    v_lshl_add_u32 v22, v3, 2, v2
    s_mov_b32 s42, 0
L_qt_49:
    ds_read_b128 v[36:39], v13 offset:3264
    ds_read_b128 v[40:43], v13 offset:3280
    s_add_u32 s42, s42, 1
    s_waitcnt lgkmcnt(0)
    v_min3_u32 v36, v36, v38, v40
    v_min_u32 v36, v36, v42
    v_cmp_eq_u32 vcc, 0, v36
    s_cbranch_vccz L_qt_ok_50
    s_cmp_lt_u32 s42, 8000000
    s_cbranch_scc1 L_qt_49
L_qt_ok_50:
    s_mov_b32 s42, 0
L_qg_45:
    global_load_dwordx4 v[80:83], v60, s[28:29] sc1
    global_load_dwordx4 v[84:87], v61, s[28:29] sc1
    global_load_dwordx4 v[88:91], v62, s[28:29] sc1
    global_load_dwordx4 v[92:95], v63, s[28:29] sc1
    s_add_u32 s42, s42, 1
    s_waitcnt vmcnt(0)
    v_xor_b32 v36, v56, v80
    v_xor_b32 v37, v57, v81
    v_bitop3_b32 v36, v36, v82, v58 bitop3:0xf6
    v_bitop3_b32 v37, v37, v83, v59 bitop3:0xf6
    v_bitop3_b32 v36, v36, v84, v56 bitop3:0xf6
    v_bitop3_b32 v37, v37, v85, v57 bitop3:0xf6
    v_bitop3_b32 v36, v36, v86, v58 bitop3:0xf6
    v_bitop3_b32 v37, v37, v87, v59 bitop3:0xf6
    v_bitop3_b32 v36, v36, v88, v56 bitop3:0xf6
    v_bitop3_b32 v37, v37, v89, v57 bitop3:0xf6
    v_bitop3_b32 v36, v36, v90, v58 bitop3:0xf6
    v_bitop3_b32 v37, v37, v91, v59 bitop3:0xf6
    v_bitop3_b32 v36, v36, v92, v56 bitop3:0xf6
    v_bitop3_b32 v37, v37, v93, v57 bitop3:0xf6
    v_bitop3_b32 v36, v36, v94, v58 bitop3:0xf6
    v_bitop3_b32 v37, v37, v95, v59 bitop3:0xf6
    v_or_b32 v36, v36, v37
    v_and_b32 v37, 7, v36
    v_and_b32 v36, 15, v36
    v_cmp_ne_u32 vcc, 0, v37
    s_cbranch_vccz L_qg_ok_46
    s_cmp_lg_u32 s42, 3
    s_cbranch_scc1 L_qg_nosc1_47
    global_store_dwordx4 v21, v[52:55], s[28:29] sc1
L_qg_nosc1_47:
    s_cmp_lt_u32 s42, 400000
    s_cbranch_scc1 L_qg_45
L_qg_ok_46:
    v_and_b32 v80, -16, v80
    v_and_b32 v81, -16, v81
    v_and_b32 v82, -16, v82
    v_and_b32 v83, -16, v83
    v_and_b32 v84, -16, v84
    v_and_b32 v85, -16, v85
    v_and_b32 v86, -16, v86
    v_and_b32 v87, -16, v87
    v_and_b32 v88, -16, v88
    v_and_b32 v89, -16, v89
    v_and_b32 v90, -16, v90
    v_and_b32 v91, -16, v91
    v_and_b32 v92, -16, v92
    v_and_b32 v93, -16, v93
    v_and_b32 v94, -16, v94
    v_and_b32 v95, -16, v95
    v_pk_add_f32 v[80:81], v[80:81], v[84:85]
    v_pk_add_f32 v[82:83], v[82:83], v[86:87]
    v_pk_add_f32 v[88:89], v[88:89], v[92:93]
    v_pk_add_f32 v[90:91], v[90:91], v[94:95]
    v_pk_add_f32 v[80:81], v[80:81], v[88:89]
    v_pk_add_f32 v[82:83], v[82:83], v[90:91]
    s_nop 1
    v_permlane32_swap_b32 v80, v82
    v_permlane32_swap_b32 v81, v83
    v_pk_add_f32 v[80:81], v[80:81], v[82:83]
    v_cvt_pk_bf16_f32 v80, v80, v81
    ds_write_b32 v22, v80 offset:2816
    v_cmp_ne_u32 vcc, 0, v36
    v_mov_b32 v14, s44
    s_nop 0
    s_cmp_lg_u64 vcc, 0
    s_cselect_b32 s46, 1, 0
    s_cselect_b32 s35, 1, 101
    v_mov_b32 v15, s35
    s_waitcnt lgkmcnt(0)
    ds_write_b64 v13, v[14:15] offset:3216
    s_cbranch_scc0 L_qg_fast_48
    global_store_dwordx4 v21, v[52:55], s[28:29] sc1
L_qg_fast_48:
    s_cmp_eq_u32 s58, 31
    s_cbranch_scc1 L_zflag_52
L_zflag_52_r:
    s_mov_b32 s40, 0x3fb8aa3b
    s_lshl_b32 s35, s33, 4
    s_add_u32 s35, s35, s45
    s_add_u32 s36, s35, 4096
    v_mov_b32 v20, s36
    s_and_b32 s36, s33, 4
    s_lshl_b32 s36, s36, 4
    s_add_u32 s35, s35, s36
    v_lshrrev_b32 v2, 2, v0
    v_lshl_add_u32 v21, v2, 8, s35
    v_and_b32 v2, 2, v0
    v_lshl_add_u32 v21, v2, 5, v21
    v_and_b32 v2, 1, v0
    v_lshl_add_u32 v21, v2, 3, v21
    s_setprio 0
    s_mov_b32 s42, 0
L_mw_53:
    ds_read_b128 v[36:39], v13 offset:3072
    ds_read_b128 v[40:43], v13 offset:3088
    s_add_u32 s42, s42, 1
    s_waitcnt lgkmcnt(0)
    v_min3_u32 v44, v37, v39, v41
    v_min_u32 v44, v44, v43
    v_cmp_eq_u32 vcc, 0, v44
    s_cbranch_vccz L_mw_ok_54
    s_cmp_lt_u32 s42, 8000000
    s_cbranch_scc1 L_mw_53
L_mw_ok_54:
    s_setprio 3
    v_max3_f32 v44, v36, v38, v40
    v_max_f32 v44, v44, v42
    v_sub_f32 v36, v36, v44
    v_sub_f32 v38, v38, v44
    v_sub_f32 v40, v40, v44
    v_sub_f32 v42, v42, v44
    v_mul_f32 v36, s40, v36
    v_mul_f32 v38, s40, v38
    v_mul_f32 v40, s40, v40
    v_mul_f32 v42, s40, v42
    v_exp_f32 v36, v36
    v_exp_f32 v38, v38
    v_exp_f32 v40, v40
    v_exp_f32 v42, v42
    v_mul_f32 v46, v36, v37
    v_mov_b32 v45, s44
    v_fmac_f32 v46, v38, v39
    v_mov_b32 v47, s44
    v_fmac_f32 v46, v40, v41
    v_fmac_f32 v46, v42, v43
    s_cmp_lg_u32 s46, 0
    s_cbranch_scc1 L_ml_slow_55
    global_store_dwordx4 v20, v[44:47], s[28:29]
    s_branch L_ml_done_56
L_ml_slow_55:
    global_store_dwordx4 v20, v[44:47], s[28:29] sc1
L_ml_done_56:
    s_barrier
    ds_read2st64_b64 v[48:51], v1 offset0:8 offset1:9
    ds_read2st64_b64 v[52:55], v1 offset0:10 offset1:11
    ds_read2st64_b64 v[56:59], v1 offset0:12 offset1:13
    ds_read2st64_b64 v[60:63], v1 offset0:14 offset1:15
    s_cmp_lg_u32 s46, 0
    s_waitcnt lgkmcnt(2)
    v_pk_add_f32 v[48:49], v[48:49], v[50:51]
    v_pk_add_f32 v[52:53], v[52:53], v[54:55]
    v_pk_mul_f32 v[48:49], v[48:49], v[36:37] op_sel_hi:[1,0]
    s_waitcnt lgkmcnt(0)
    v_pk_add_f32 v[56:57], v[56:57], v[58:59]
    v_pk_fma_f32 v[48:49], v[52:53], v[38:39], v[48:49] op_sel_hi:[1,0,1]
    v_pk_add_f32 v[60:61], v[60:61], v[62:63]
    v_pk_fma_f32 v[48:49], v[56:57], v[40:41], v[48:49] op_sel_hi:[1,0,1]
    v_pk_fma_f32 v[48:49], v[60:61], v[42:43], v[48:49] op_sel_hi:[1,0,1]
    v_and_or_b32 v48, v48, s49, v246
    v_and_or_b32 v49, v49, s49, v247
    s_cbranch_scc1 L_op_slow_57
    global_store_dwordx2 v21, v[48:49], s[28:29]
L_op_done_58:
    s_cmp_lg_u32 s31, 0
    s_cbranch_scc1 L_ctrl_n
    s_barrier
    global_load_dword v24, v23, s[28:29] sc1
    v_mul_u32_u24 v2, 640, v0
    s_lshl_b32 s35, s33, 7
    s_add_u32 s35, s35, 40960
    v_add_u32 v2, s35, v2
    v_mov_b32 v3, 1
    s_waitcnt vmcnt(0)
    s_mov_b32 s42, 0
L_zc_63:
    v_xor_b32 v24, s44, v24
    v_lshlrev_b32 v24, 3, v24
    v_cmp_ne_u32 vcc, 0, v24
    s_cbranch_vccnz L_zc_re_64
L_zc_ok_65:
    s_mov_b32 exec_lo, 0x7ffffff
    s_mov_b32 exec_hi, 0x0
    s_barrier
    global_atomic_add v2, v3, s[28:29] sc1
    s_barrier
    s_endpgm
L_zinit_51:
    s_mul_i32 s35, s30, 5120
    s_add_u32 s35, s35, 2048
    v_lshl_add_u32 v2, v0, 4, s35
    s_mov_b32 s35, 374865920
    s_cmp_ge_u32 s30, 4
    s_cmov_b32 s35, 1561329664
    v_mov_b32 v64, 0
    v_mov_b32 v65, s35
    v_mov_b32 v66, 0
    v_mov_b32 v67, s35
    global_store_dwordx4 v2, v[64:67], s[28:29] offset:-2048 sc1
    global_store_dwordx4 v2, v[64:67], s[28:29] offset:-1024 sc1
    global_store_dwordx4 v2, v[64:67], s[28:29] sc1
    global_store_dwordx4 v2, v[64:67], s[28:29] offset:1024 sc1
    global_store_dwordx4 v2, v[64:67], s[28:29] offset:2048 sc1
    s_mul_i32 s35, s30, 5120
    s_add_u32 s35, s35, 40960
    v_min_u32 v2, 39, v0
    v_lshl_add_u32 v2, v2, 7, s35
    global_store_dword v2, v64, s[28:29] sc1
    s_branch L_zinit_51_r
L_zflag_52:
    s_lshl_b32 s35, s30, 2
    s_add_u32 s35, s35, 528384
    v_mov_b32 v2, s35
    s_waitcnt vmcnt(0)
    global_store_dword v2, v245, s[28:29] sc1
    s_branch L_zflag_52_r
L_op_slow_57:
    global_store_dwordx2 v21, v[48:49], s[28:29] sc1
    s_branch L_op_done_58
L_zc_re_64:
    global_load_dword v24, v23, s[28:29] sc1
    s_add_u32 s42, s42, 1
    s_cmp_ge_u32 s42, 400000
    s_waitcnt vmcnt(0)
    s_cbranch_scc1 L_zc_ok_65
    s_branch L_zc_63
L_ctrl_n:
    s_cmp_eq_u32 s31, 1
    s_cbranch_scc1 L_notfree_59
    s_endpgm
L_notfree_59:
    global_load_dword v24, v23, s[28:29] sc1
    s_barrier
    s_waitcnt vmcnt(0)
    s_mov_b32 s42, 0
L_zc_66:
    v_xor_b32 v24, s44, v24
    v_lshlrev_b32 v24, 3, v24
    v_cmp_ne_u32 vcc, 0, v24
    s_cbranch_vccnz L_zc_re_67
L_zc_ok_68:
    s_mov_b64 exec, 0
    s_branch L_dry_in
L_dry_out:
    s_mov_b64 exec, -1
    s_mov_b32 s38, s39
    s_mul_i32 s38, s38, 640
    s_add_u32 s38, s38, 40960
    s_mov_b32 s42, 40
    s_mov_b64 s[64:65], 0
    s_mov_b64 s[66:67], 0
    s_mov_b32 s68, 0
L_probe_69:
    s_cmp_eq_u32 s64, 32
    s_cbranch_scc1 L_psk_71
    s_load_dword s64, s[28:29], s38 offset:0 glc
L_psk_71:
    s_cmp_eq_u32 s65, 32
    s_cbranch_scc1 L_psk_72
    s_load_dword s65, s[28:29], s38 offset:128 glc
L_psk_72:
    s_cmp_eq_u32 s66, 32
    s_cbranch_scc1 L_psk_73
    s_load_dword s66, s[28:29], s38 offset:256 glc
L_psk_73:
    s_cmp_eq_u32 s67, 32
    s_cbranch_scc1 L_psk_74
    s_load_dword s67, s[28:29], s38 offset:384 glc
L_psk_74:
    s_cmp_eq_u32 s68, 32
    s_cbranch_scc1 L_psk_75
    s_load_dword s68, s[28:29], s38 offset:512 glc
L_psk_75:
    s_sub_u32 s42, s42, 1
    s_cmp_eq_u32 s42, 0
    s_cbranch_scc1 L_probe_ok_70
    s_waitcnt lgkmcnt(0)
    s_and_b64 s[70:71], s[64:65], s[66:67]
    s_and_b32 s70, s70, s68
    s_and_b32 s70, s70, s71
    s_bitcmp0_b32 s70, 5
    s_cbranch_scc1 L_probe_69
L_probe_ok_70:
    s_barrier
    s_endpgm
L_zc_re_67:
    global_load_dword v24, v23, s[28:29] sc1
    s_add_u32 s42, s42, 1
    s_cmp_ge_u32 s42, 400000
    s_waitcnt vmcnt(0)
    s_cbranch_scc1 L_zc_ok_68
    s_branch L_zc_66
L_exit:
    s_endpgm
L_codeend:
.section .rodata,"a"
.p2align 6
.amdhsa_kernel sequential_preLN__sliding_block_cached__mixer_channel_mlp__decode_kernel
  .amdhsa_next_free_vgpr 256
  .amdhsa_next_free_sgpr 102
  .amdhsa_accum_offset 256
  .amdhsa_group_segment_fixed_size 0
  .amdhsa_kernarg_size 104
  .amdhsa_user_sgpr_count 2
  .amdhsa_user_sgpr_kernarg_segment_ptr 1
  .amdhsa_system_sgpr_workgroup_id_x 1
  .amdhsa_float_denorm_mode_32 3
  .amdhsa_float_denorm_mode_16_64 3
.end_amdhsa_kernel
```
